```python
import torch

def _softmax(x, axis=-1):
    return torch.softmax(x, dim=axis)
def _gelu(x):
    return torch.nn.functional.gelu(x, approximate="tanh")
def _silu(x):
    return torch.nn.functional.silu(x)
def _sigmoid(x):
    return torch.sigmoid(x)
def _layernorm(x, axis=-1, eps=1e-5):
    m = x.mean(dim=axis, keepdim=True)
    v = x.var(dim=axis, keepdim=True, unbiased=False)
    return (x - m) / torch.sqrt(v + eps)
def _scatter_add(tgt, idx, src, axis=0):
    return tgt.clone().index_add_(axis, idx, src)
def _segment_sum(src, seg, n):
    out = torch.zeros((n,) + src.shape[1:], dtype=src.dtype)
    return out.index_add_(0, seg, src)
def _pad(x, pw):
    flat = tuple(v for pair in reversed(pw) for v in pair)
    return torch.nn.functional.pad(x, flat)

kernel_name = 'parallel_sum__sliding_block__glu_gated_geglu__prompt'

def setup_inputs():

    _w = (lambda a: (lambda t: t.to(torch.bfloat16) if t.is_floating_point() else t)(torch.as_tensor(a)))
    def _A_setup():
        B, S, D = 1, 2048, 512
        return {
            "x": _w((lambda *s: torch.randn(*s, dtype=torch.bfloat16) * 0.05)(B, S, D)),
            "wqkv": _w((lambda *s: torch.randn(*s, dtype=torch.bfloat16) * 0.05)(D, 3 * D)),
            "wo": _w((lambda *s: torch.randn(*s, dtype=torch.bfloat16) * 0.05)(D, D)),
        }
    _A_in = _A_setup()

    def _B_setup():
        B, S, Dm, Df = 1, 2048, 512, 1792
        return {
            "x": _w((lambda *s: torch.randn(*s, dtype=torch.bfloat16) * 0.05)(B, S, Dm)),
            "w_gate": _w((lambda *s: torch.randn(*s, dtype=torch.bfloat16) * 0.8)(Dm, Df) * (Dm ** -0.5)),
            "w_up": _w((lambda *s: torch.randn(*s, dtype=torch.bfloat16) * 0.8)(Dm, Df) * (Dm ** -0.5)),
            "w_down": _w((lambda *s: torch.randn(*s, dtype=torch.bfloat16) * 0.8)(Df, Dm) * (Df ** -0.5)),
        }
    _B_in = _B_setup()

    return {
        "A_x": _A_in["x"],
        "A_wqkv": _A_in["wqkv"],
        "A_wo": _A_in["wo"],
        "B_x": _B_in["x"],
        "B_w_gate": _B_in["w_gate"],
        "B_w_up": _B_in["w_up"],
        "B_w_down": _B_in["w_down"],
    }

def reference(A_x, A_wqkv, A_wo, B_x, B_w_gate, B_w_up, B_w_down):
    def _A_ref(x, wqkv, wo):
        B, S, D = x.shape
        H = 32; Dh = D // H; W = 256
        qkv = (lambda x, *d: x.permute(*d))((x @ wqkv).reshape(B, S, 3, H, Dh), 2, 0, 3, 1, 4)
        q, k, v = qkv[0], qkv[1], qkv[2]
        scores = torch.einsum("bhqd,bhkd->bhqk", q, k) * (Dh ** -0.5)
        idx = torch.arange(S)
        mask = (idx[:, None] - idx[None, :] >= 0) & (idx[:, None] - idx[None, :] < W)
        scores = torch.where(mask[None, None], scores, -1e9)
        p = _softmax(scores, axis=-1)
        o = torch.einsum("bhqk,bhkd->bhqd", p, v)
        return (lambda x, *d: x.permute(*d))(o, 0, 2, 1, 3).reshape(B, S, D) @ wo

    def _B_ref(x, w_gate, w_up, w_down):
        g = torch.einsum("bsd,df->bsf", x, w_gate)
        u = torch.einsum("bsd,df->bsf", x, w_up)
        h = _gelu(g) * u
        return torch.einsum("bsf,fd->bsd", h, w_down)

    x = A_x
    xn = _layernorm(x, axis=-1)
    return x + _A_ref(xn, A_wqkv, A_wo) + _B_ref(xn, B_w_gate, B_w_up, B_w_down)
```

```asm
; @launch kernel=k1_kernel grid=(256,1,1) block=(512,1,1) lds=145536
; @launch kernel=k2_kernel grid=(256,1,1) block=(512,1,1) lds=69888
.amdgcn_target "amdgcn-amd-amdhsa--gfx950"
.text
.globl k1_kernel
.p2align 8
.type k1_kernel,@function
k1_kernel:
  s_cmp_ge_u32 s2, 256
  s_cbranch_scc1 K1_END
  s_load_dwordx2 s[4:5], s[0:1], 0
  s_load_dwordx2 s[28:29], s[0:1], 8
  s_load_dwordx4 s[32:35], s[0:1], 32
  s_load_dwordx2 s[16:17], s[0:1], 72
  s_load_dwordx2 s[96:97], s[0:1], 16
  s_load_dwordx2 s[60:61], s[0:1], 48
  v_lshrrev_b32 v1, 6, v0
  v_and_b32 v0, 63, v0
  v_readfirstlane_b32 s20, v1
  s_and_b32 s36, s2, 7
  s_lshr_b32 s37, s2, 3
  s_and_b32 s38, s36, 1
  s_lshl_b32 s38, s38, 2
  s_and_b32 s39, s37, 3
  s_add_u32 s21, s38, s39
  s_lshr_b32 s38, s36, 1
  s_lshl_b32 s38, s38, 3
  s_lshr_b32 s39, s37, 2
  s_add_u32 s22, s38, s39
  s_lshr_b32 s30, s22, 1
  s_and_b32 s23, s22, 1
  s_mul_i32 s31, s30, 112
  s_mul_i32 s38, s23, 48
  s_add_u32 s31, s31, s38
  s_lshl_b32 s21, s21, 3
  s_add_u32 s21, s21, s20
  s_lshl_b32 s24, s21, 15
  s_add_u32 s25, s24, 8192
  s_add_u32 s26, s24, 16384
  s_add_u32 s27, s24, 24576
  s_lshl_b32 s47, s20, 13
  s_add_u32 s47, s47, 6144
  v_lshrrev_b32 v2, 3, v0
  v_and_b32 v3, 7, v0
  v_lshrrev_b32 v4, 4, v0
  v_xor_b32 v3, v3, v4
  v_lshlrev_b32 v3, 4, v3
  v_lshl_add_u32 v2, v2, 10, v3
  v_xor_b32 v3, 64, v2
  v_add_u32 v31, 0, v0
  v_mul_u32_u24 v32, 43691, v31
  v_lshrrev_b32 v32, 18, v32
  v_mul_u32_u24 v33, 6, v32
  v_sub_u32 v33, v31, v33
  v_mul_u32_u24 v32, 3584, v32
  v_lshl_add_u32 v9, v33, 4, v32
  v_add_u32 v31, 64, v0
  v_mul_u32_u24 v32, 43691, v31
  v_lshrrev_b32 v32, 18, v32
  v_mul_u32_u24 v33, 6, v32
  v_sub_u32 v33, v31, v33
  v_mul_u32_u24 v32, 3584, v32
  v_lshl_add_u32 v10, v33, 4, v32
  v_add_u32 v31, 128, v0
  v_mul_u32_u24 v32, 43691, v31
  v_lshrrev_b32 v32, 18, v32
  v_mul_u32_u24 v33, 6, v32
  v_sub_u32 v33, v31, v33
  v_mul_u32_u24 v32, 3584, v32
  v_lshl_add_u32 v11, v33, 4, v32
  s_waitcnt lgkmcnt(0)
  s_mov_b32 s6, 0x200000
  s_mov_b32 s7, 0x20000
  s_mov_b32 s18, 33554432
  s_mov_b32 s19, 0x20000
  s_cmp_lt_u32 s20, 4
  s_cselect_b32 s8, s32, s34
  s_cselect_b32 s9, s33, s35
  s_mov_b32 s10, 1835008
  s_mov_b32 s11, 0x20000
  s_mov_b32 s41, 71680
  s_cselect_b32 s41, s41, 108672
  s_and_b32 s36, s20, 3
  s_mul_i32 s40, s36, 114688
  s_lshl_b32 s37, s31, 1
  s_add_u32 s40, s40, s37
  s_mul_i32 s37, s36, 3072
  s_add_u32 s41, s41, s37
  s_add_u32 s55, s40, 0
  s_add_u32 m0, s41, 0
  s_nop 0
  buffer_load_dwordx4 v9, s[8:11], s55 offen lds
  s_add_u32 m0, s41, 1024
  s_nop 0
  buffer_load_dwordx4 v10, s[8:11], s55 offen lds
  s_add_u32 m0, s41, 2048
  s_nop 0
  buffer_load_dwordx4 v11, s[8:11], s55 offen lds
  s_add_u32 m0, s47, 0
  s_nop 0
  buffer_load_dwordx4 v2, s[4:7], s24 offen offset:0 lds
  s_add_u32 m0, s47, 1024
  s_nop 0
  buffer_load_dwordx4 v3, s[4:7], s25 offen offset:0 lds
  s_add_u32 m0, s47, 2048
  s_nop 0
  buffer_load_dwordx4 v2, s[4:7], s26 offen offset:0 lds
  s_add_u32 m0, s47, 3072
  s_nop 0
  buffer_load_dwordx4 v3, s[4:7], s27 offen offset:0 lds
  s_add_u32 m0, s47, 3968
  s_nop 0
  buffer_load_dwordx4 v2, s[4:7], s24 offen offset:128 lds
  s_add_u32 m0, s47, 4992
  s_nop 0
  buffer_load_dwordx4 v3, s[4:7], s25 offen offset:128 lds
  s_add_u32 m0, s47, 6016
  s_nop 0
  buffer_load_dwordx4 v2, s[4:7], s26 offen offset:128 lds
  s_add_u32 m0, s47, 7040
  s_nop 0
  buffer_load_dwordx4 v3, s[4:7], s27 offen offset:128 lds
  v_and_b32 v4, 31, v0
  v_lshrrev_b32 v5, 5, v0
  v_lshrrev_b32 v6, 1, v4
  v_and_b32 v6, 7, v6
  v_xor_b32 v6, v6, v5
  v_lshlrev_b32 v6, 4, v6
  v_lshl_add_u32 v4, v4, 7, v6
  v_add_u32 v4, s47, v4
  v_xor_b32 v5, 32, v4
  v_xor_b32 v6, 64, v4
  v_xor_b32 v7, 0x60, v4
  v_bfe_u32 v28, v0, 4, 1
  v_lshrrev_b32 v29, 5, v0
  v_lshlrev_b32 v29, 3, v29
  v_bfe_u32 v30, v0, 2, 2
  v_add_u32 v29, v29, v30
  v_and_b32 v30, 3, v0
  v_lshlrev_b32 v30, 3, v30
  v_mul_u32_u24 v8, 36992, v28
  v_mul_u32_u24 v31, 96, v29
  v_add3_u32 v8, v8, v31, v30
  v_add_u32 v8, 71680, v8
  s_mul_i32 s36, s20, 1536
  v_add_u32 v1, s36, v8
  v_lshlrev_b32 v13, 6, v29
  v_lshl_add_u32 v13, v28, 5, v13
  v_add_u32 v13, v13, v30
  v_lshlrev_b32 v22, 4, v0
  v_and_b32 v31, 15, v0
  v_cmp_eq_u32 vcc, v31, v28
  v_mov_b32 v96, 0x3f803f80
  s_nop 0
  v_cndmask_b32 v96, 0, v96, vcc
  v_mov_b32 v97, v96
  v_mov_b32 v98, v96
  v_mov_b32 v99, v96
  v_mov_b32 v15, 0
  v_mov_b32 v16, 0
  s_mov_b32 s15, 0x20000
  s_cmp_ge_u32 s20, 4
  s_cselect_b32 s46, 1, 0
  s_cmp_lt_u32 s20, 4
  s_cbranch_scc1 K1_P2_QKV
  s_cmp_eq_u32 s23, 0
  s_cbranch_scc1 K1_P2_QKV
  s_cmp_lt_u32 s20, 6
  s_cselect_b32 s12, s32, s34
  s_cselect_b32 s13, s33, s35
  s_cselect_b32 s37, 0, 4224
  s_mov_b32 s14, 1835008
  v_lshrrev_b32 v31, 1, v0
  v_mul_u32_u24 v31, 3584, v31
  v_and_b32 v12, 1, v0
  v_lshl_add_u32 v12, v12, 4, v31
  s_and_b32 s36, s20, 1
  s_mul_i32 s42, s36, 229376
  s_mul_i32 s38, s30, 224
  s_add_u32 s42, s42, s38
  s_add_u32 s42, s42, 192
  s_mov_b32 s43, 458752
  s_mov_b32 s44, 114688
  s_lshl_b32 s36, s36, 11
  s_add_u32 s45, s37, s36
  s_branch K1_P2_DONE
K1_P2_QKV:
  s_mov_b32 s12, s28
  s_mov_b32 s13, s29
  s_mov_b32 s14, 1572864
  v_lshrrev_b32 v31, 2, v0
  v_mul_u32_u24 v31, 3072, v31
  v_and_b32 v12, 3, v0
  v_lshl_add_u32 v12, v12, 4, v31
  s_and_b32 s36, s20, 3
  s_mul_i32 s42, s36, 98304
  s_lshl_b32 s37, s22, 6
  s_lshl_b32 s38, s30, 6
  s_add_u32 s38, s38, 2048
  s_lshl_b32 s45, s36, 11
  s_cmp_lt_u32 s20, 4
  s_cselect_b32 s37, s37, s38
  s_add_u32 s42, s42, s37
  s_mov_b32 s43, 393216
  s_mov_b32 s44, 49152
K1_P2_DONE:
  s_cmp_eq_u32 s23, 0
  s_cbranch_scc1 K1_XA
  v_mul_u32_u24 v14, 4224, v28
  v_lshl_add_u32 v14, v29, 5, v14
  v_add_u32 v14, v14, v30
  s_branch K1_XB
K1_XA:
  v_mov_b32 v14, v13
K1_XB:
  v_add_u32 v23, 14336, v14
  v_add_u32 v14, 108672, v14
  v_add_u32 v21, 6144, v13
  v_add_u32 v13, 71680, v13
  s_mul_i32 s48, s21, 112
  s_lshr_b32 s36, s31, 4
  s_add_u32 s48, s48, s36
  s_lshl_b32 s48, s48, 10
  s_add_u32 s48, s48, 6291456
  s_and_b32 s36, s22, 15
  s_lshl_b32 s36, s36, 7
  s_add_u32 s36, s36, s21
  s_lshl_b32 s36, s36, 10
  s_cmp_lt_u32 s22, 16
  s_cselect_b32 s37, 0, 2097152
  s_cselect_b32 s51, 0x3eb8aa3b, 0x3f800000
  s_add_u32 s49, s36, s37
  s_lshl_b32 s36, s30, 7
  s_add_u32 s36, s36, s21
  s_lshl_b32 s36, s36, 10
  s_add_u32 s36, s36, 4194304
  s_add_u32 s37, s48, 3072
  s_cmp_eq_u32 s23, 0
  s_cselect_b32 s50, s36, s37
  s_cmp_ge_u32 s20, 3
  s_cbranch_scc1 K1_TCA
  s_getpc_b64 s[52:53]
K1_TCAP:
  s_sub_u32 s52, s52, K1_TCAP-k1_kernel
  s_subb_u32 s53, s53, 0
  s_lshl_b32 s56, s20, 13
  s_add_u32 s56, s56, 0
  v_lshl_add_u32 v31, v0, 7, s56
  v_min_u32 v31, CODE_END-k1_kernel-4, v31
  global_load_dword v255, v31, s[52:53]
K1_TCA:
  s_lshl_b32 s59, s2, 3
  s_add_u32 s59, s59, s20
  s_lshl_b32 s59, s59, 10
  s_mov_b32 s88, s32
  s_mov_b32 s89, s33
  s_mov_b32 s90, 1835008
  s_mov_b32 s91, 0x20000
  buffer_load_dwordx4 v[252:255], v22, s[88:91], s59 offen
  s_mov_b32 s88, s34
  s_mov_b32 s89, s35
  s_mov_b32 s90, 1835008
  s_mov_b32 s91, 0x20000
  buffer_load_dwordx4 v[252:255], v22, s[88:91], s59 offen
  s_mov_b32 s88, s28
  s_mov_b32 s89, s29
  s_mov_b32 s90, 1572864
  s_mov_b32 s91, 0x20000
  buffer_load_dwordx4 v[252:255], v22, s[88:91], s59 offen
  s_or_b32 s52, s2, s20
  s_cmp_lg_u32 s52, 0
  s_cbranch_scc1 K1_NOZ
  v_mov_b32 v32, 0
  v_mov_b32 v33, 0
  v_mov_b32 v34, 0
  v_mov_b32 v35, 0
  s_mov_b32 s52, 20971520
  buffer_store_dwordx4 v[32:35], v22, s[16:19], s52 offen offset:0
  buffer_store_dwordx4 v[32:35], v22, s[16:19], s52 offen offset:1024
  buffer_store_dwordx4 v[32:35], v22, s[16:19], s52 offen offset:2048
  buffer_store_dwordx4 v[32:35], v22, s[16:19], s52 offen offset:3072
  s_waitcnt vmcnt(0)
K1_NOZ:
  s_waitcnt vmcnt(11)
  s_barrier
  s_waitcnt vmcnt(7)
  ds_read_b128 v[128:131], v4 offset:0
  ds_read_b128 v[132:135], v5 offset:0
  ds_read_b128 v[136:139], v6 offset:0
  ds_read_b128 v[140:143], v7 offset:0
  ds_read_b64_tr_b16 v[24:25], v8 offset:0
  ds_read_b64_tr_b16 v[26:27], v8 offset:384
  ds_read_b64_tr_b16 v[28:29], v8 offset:32
  ds_read_b64_tr_b16 v[30:31], v8 offset:416
  ds_read_b64_tr_b16 v[32:33], v8 offset:64
  ds_read_b64_tr_b16 v[34:35], v8 offset:448
  s_waitcnt lgkmcnt(4)
  v_mfma_f32_32x32x16_bf16 v[48:63], v[24:27], v[128:131], 0
  ds_read_b64_tr_b16 v[36:37], v8 offset:1536
  ds_read_b64_tr_b16 v[38:39], v8 offset:1920
  v_mfma_f32_4x4x4_16b_bf16 v[16:19], v[128:129], v[128:129], 0
  s_add_u32 s55, s40, 458752
  s_add_u32 m0, s41, 12288
  s_nop 0
  buffer_load_dwordx4 v9, s[8:11], s55 offen lds
  s_waitcnt lgkmcnt(4)
  v_mfma_f32_32x32x16_bf16 v[64:79], v[28:31], v[128:131], 0
  ds_read_b64_tr_b16 v[40:41], v8 offset:1568
  ds_read_b64_tr_b16 v[42:43], v8 offset:1952
  v_mfma_f32_16x16x32_bf16 v[100:103], v[96:99], v[128:131], 0
  s_add_u32 m0, s41, 13312
  s_nop 0
  buffer_load_dwordx4 v10, s[8:11], s55 offen lds
  s_waitcnt lgkmcnt(4)
  v_mfma_f32_32x32x16_bf16 v[80:95], v[32:35], v[128:131], 0
  ds_read_b64_tr_b16 v[44:45], v8 offset:1600
  ds_read_b64_tr_b16 v[46:47], v8 offset:1984
  v_mfma_f32_4x4x4_16b_bf16 v[16:19], v[130:131], v[130:131], v[16:19]
  s_add_u32 m0, s41, 14336
  s_nop 0
  buffer_load_dwordx4 v11, s[8:11], s55 offen lds
  s_waitcnt lgkmcnt(4)
  v_mfma_f32_32x32x16_bf16 v[48:63], v[36:39], v[132:135], v[48:63]
  ds_read_b64_tr_b16 v[24:25], v8 offset:3072
  ds_read_b64_tr_b16 v[26:27], v8 offset:3456
  v_mfma_f32_4x4x4_16b_bf16 v[16:19], v[132:133], v[132:133], v[16:19]
  s_add_u32 m0, s47, -256
  s_nop 0
  buffer_load_dwordx4 v2, s[4:7], s24 offen offset:256 lds
  s_waitcnt lgkmcnt(4)
  v_mfma_f32_32x32x16_bf16 v[64:79], v[40:43], v[132:135], v[64:79]
  ds_read_b64_tr_b16 v[28:29], v8 offset:3104
  ds_read_b64_tr_b16 v[30:31], v8 offset:3488
  v_mfma_f32_16x16x32_bf16 v[100:103], v[96:99], v[132:135], v[100:103]
  s_add_u32 m0, s47, 768
  s_nop 0
  buffer_load_dwordx4 v3, s[4:7], s25 offen offset:256 lds
  s_waitcnt lgkmcnt(4)
  v_mfma_f32_32x32x16_bf16 v[80:95], v[44:47], v[132:135], v[80:95]
  ds_read_b64_tr_b16 v[32:33], v8 offset:3136
  ds_read_b64_tr_b16 v[34:35], v8 offset:3520
  v_mfma_f32_4x4x4_16b_bf16 v[16:19], v[134:135], v[134:135], v[16:19]
  s_add_u32 m0, s47, 1792
  s_nop 0
  buffer_load_dwordx4 v2, s[4:7], s26 offen offset:256 lds
  s_add_u32 m0, s47, 2816
  s_nop 0
  buffer_load_dwordx4 v3, s[4:7], s27 offen offset:256 lds
  s_waitcnt vmcnt(10)
  ds_read_b128 v[144:147], v4 offset:4096
  ds_read_b128 v[148:151], v5 offset:4096
  ds_read_b128 v[152:155], v6 offset:4096
  ds_read_b128 v[156:159], v7 offset:4096
  s_waitcnt lgkmcnt(8)
  v_mfma_f32_32x32x16_bf16 v[48:63], v[24:27], v[136:139], v[48:63]
  ds_read_b64_tr_b16 v[36:37], v8 offset:4608
  ds_read_b64_tr_b16 v[38:39], v8 offset:4992
  v_mfma_f32_4x4x4_16b_bf16 v[16:19], v[136:137], v[136:137], v[16:19]
  s_add_u32 s55, s40, 917504
  s_add_u32 m0, s41, 24576
  s_nop 0
  buffer_load_dwordx4 v9, s[8:11], s55 offen lds
  s_waitcnt lgkmcnt(8)
  v_mfma_f32_32x32x16_bf16 v[64:79], v[28:31], v[136:139], v[64:79]
  ds_read_b64_tr_b16 v[40:41], v8 offset:4640
  ds_read_b64_tr_b16 v[42:43], v8 offset:5024
  v_mfma_f32_16x16x32_bf16 v[100:103], v[96:99], v[136:139], v[100:103]
  s_add_u32 m0, s41, 25600
  s_nop 0
  buffer_load_dwordx4 v10, s[8:11], s55 offen lds
  s_waitcnt lgkmcnt(8)
  v_mfma_f32_32x32x16_bf16 v[80:95], v[32:35], v[136:139], v[80:95]
  ds_read_b64_tr_b16 v[44:45], v8 offset:4672
  ds_read_b64_tr_b16 v[46:47], v8 offset:5056
  v_mfma_f32_4x4x4_16b_bf16 v[16:19], v[138:139], v[138:139], v[16:19]
  s_add_u32 m0, s41, 26624
  s_nop 0
  buffer_load_dwordx4 v11, s[8:11], s55 offen lds
  s_waitcnt lgkmcnt(4)
  v_mfma_f32_32x32x16_bf16 v[48:63], v[36:39], v[140:143], v[48:63]
  ds_read_b64_tr_b16 v[24:25], v8 offset:6144
  ds_read_b64_tr_b16 v[26:27], v8 offset:6528
  v_mfma_f32_4x4x4_16b_bf16 v[16:19], v[140:141], v[140:141], v[16:19]
  s_add_u32 m0, s47, 3712
  s_nop 0
  buffer_load_dwordx4 v2, s[4:7], s24 offen offset:384 lds
  s_waitcnt lgkmcnt(4)
  v_mfma_f32_32x32x16_bf16 v[64:79], v[40:43], v[140:143], v[64:79]
  ds_read_b64_tr_b16 v[28:29], v8 offset:6176
  ds_read_b64_tr_b16 v[30:31], v8 offset:6560
  v_mfma_f32_16x16x32_bf16 v[100:103], v[96:99], v[140:143], v[100:103]
  s_add_u32 m0, s47, 4736
  s_nop 0
  buffer_load_dwordx4 v3, s[4:7], s25 offen offset:384 lds
  s_waitcnt lgkmcnt(4)
  v_mfma_f32_32x32x16_bf16 v[80:95], v[44:47], v[140:143], v[80:95]
  ds_read_b64_tr_b16 v[32:33], v8 offset:6208
  ds_read_b64_tr_b16 v[34:35], v8 offset:6592
  v_mfma_f32_4x4x4_16b_bf16 v[16:19], v[142:143], v[142:143], v[16:19]
  s_add_u32 m0, s47, 5760
  s_nop 0
  buffer_load_dwordx4 v2, s[4:7], s26 offen offset:384 lds
  s_add_u32 m0, s47, 6784
  s_nop 0
  buffer_load_dwordx4 v3, s[4:7], s27 offen offset:384 lds
  s_waitcnt lgkmcnt(4)
  v_mfma_f32_32x32x16_bf16 v[48:63], v[24:27], v[144:147], v[48:63]
  ds_read_b64_tr_b16 v[36:37], v8 offset:7680
  ds_read_b64_tr_b16 v[38:39], v8 offset:8064
  v_mfma_f32_4x4x4_16b_bf16 v[16:19], v[144:145], v[144:145], v[16:19]
  s_waitcnt lgkmcnt(4)
  v_mfma_f32_32x32x16_bf16 v[64:79], v[28:31], v[144:147], v[64:79]
  ds_read_b64_tr_b16 v[40:41], v8 offset:7712
  ds_read_b64_tr_b16 v[42:43], v8 offset:8096
  v_mfma_f32_16x16x32_bf16 v[100:103], v[96:99], v[144:147], v[100:103]
  s_waitcnt lgkmcnt(4)
  v_mfma_f32_32x32x16_bf16 v[80:95], v[32:35], v[144:147], v[80:95]
  ds_read_b64_tr_b16 v[44:45], v8 offset:7744
  ds_read_b64_tr_b16 v[46:47], v8 offset:8128
  v_mfma_f32_4x4x4_16b_bf16 v[16:19], v[146:147], v[146:147], v[16:19]
  s_waitcnt lgkmcnt(4)
  v_mfma_f32_32x32x16_bf16 v[48:63], v[36:39], v[148:151], v[48:63]
  ds_read_b64_tr_b16 v[24:25], v8 offset:9216
  ds_read_b64_tr_b16 v[26:27], v8 offset:9600
  v_mfma_f32_4x4x4_16b_bf16 v[16:19], v[148:149], v[148:149], v[16:19]
  s_waitcnt lgkmcnt(4)
  v_mfma_f32_32x32x16_bf16 v[64:79], v[40:43], v[148:151], v[64:79]
  ds_read_b64_tr_b16 v[28:29], v8 offset:9248
  ds_read_b64_tr_b16 v[30:31], v8 offset:9632
  v_mfma_f32_16x16x32_bf16 v[100:103], v[96:99], v[148:151], v[100:103]
  s_waitcnt lgkmcnt(4)
  v_mfma_f32_32x32x16_bf16 v[80:95], v[44:47], v[148:151], v[80:95]
  ds_read_b64_tr_b16 v[32:33], v8 offset:9280
  ds_read_b64_tr_b16 v[34:35], v8 offset:9664
  v_mfma_f32_4x4x4_16b_bf16 v[16:19], v[150:151], v[150:151], v[16:19]
  ds_read_b64_tr_b16 v[116:117], v1 offset:0
  ds_read_b64_tr_b16 v[118:119], v1 offset:384
  ds_read_b64_tr_b16 v[120:121], v1 offset:32
  ds_read_b64_tr_b16 v[122:123], v1 offset:416
  ds_read_b64_tr_b16 v[124:125], v1 offset:64
  ds_read_b64_tr_b16 v[126:127], v1 offset:448
  s_waitcnt vmcnt(7)
  ds_read_b128 v[160:163], v4 offset:0
  ds_read_b128 v[164:167], v5 offset:0
  ds_read_b128 v[168:171], v6 offset:0
  ds_read_b128 v[172:175], v7 offset:0
  s_waitcnt lgkmcnt(14)
  v_mfma_f32_32x32x16_bf16 v[48:63], v[24:27], v[152:155], v[48:63]
  ds_read_b64_tr_b16 v[36:37], v8 offset:10752
  ds_read_b64_tr_b16 v[38:39], v8 offset:11136
  v_mfma_f32_4x4x4_16b_bf16 v[16:19], v[152:153], v[152:153], v[16:19]
  s_waitcnt lgkmcnt(14)
  v_mfma_f32_32x32x16_bf16 v[64:79], v[28:31], v[152:155], v[64:79]
  ds_read_b64_tr_b16 v[40:41], v8 offset:10784
  ds_read_b64_tr_b16 v[42:43], v8 offset:11168
  v_mfma_f32_16x16x32_bf16 v[100:103], v[96:99], v[152:155], v[100:103]
  s_waitcnt lgkmcnt(14)
  v_mfma_f32_32x32x16_bf16 v[80:95], v[32:35], v[152:155], v[80:95]
  ds_read_b64_tr_b16 v[44:45], v8 offset:10816
  ds_read_b64_tr_b16 v[46:47], v8 offset:11200
  v_mfma_f32_4x4x4_16b_bf16 v[16:19], v[154:155], v[154:155], v[16:19]
  s_waitcnt lgkmcnt(10)
  v_mfma_f32_16x16x32_bf16 v[104:107], v[96:99], v[116:119], 0
  v_mfma_f32_16x16x32_bf16 v[108:111], v[96:99], v[120:123], 0
  v_mfma_f32_16x16x32_bf16 v[112:115], v[96:99], v[124:127], 0
  s_waitcnt lgkmcnt(0)
  s_barrier
  v_mfma_f32_32x32x16_bf16 v[48:63], v[36:39], v[156:159], v[48:63]
  ds_read_b64_tr_b16 v[24:25], v8 offset:12288
  ds_read_b64_tr_b16 v[26:27], v8 offset:12672
  v_mfma_f32_4x4x4_16b_bf16 v[16:19], v[156:157], v[156:157], v[16:19]
  s_add_u32 s55, s40, 1376256
  s_add_u32 m0, s41, 0
  s_nop 0
  buffer_load_dwordx4 v9, s[8:11], s55 offen lds
  v_mfma_f32_32x32x16_bf16 v[64:79], v[40:43], v[156:159], v[64:79]
  ds_read_b64_tr_b16 v[28:29], v8 offset:12320
  ds_read_b64_tr_b16 v[30:31], v8 offset:12704
  v_mfma_f32_16x16x32_bf16 v[100:103], v[96:99], v[156:159], v[100:103]
  s_add_u32 m0, s41, 1024
  s_nop 0
  buffer_load_dwordx4 v10, s[8:11], s55 offen lds
  v_mfma_f32_32x32x16_bf16 v[80:95], v[44:47], v[156:159], v[80:95]
  ds_read_b64_tr_b16 v[32:33], v8 offset:12352
  ds_read_b64_tr_b16 v[34:35], v8 offset:12736
  v_mfma_f32_4x4x4_16b_bf16 v[16:19], v[158:159], v[158:159], v[16:19]
  s_add_u32 m0, s41, 2048
  s_nop 0
  buffer_load_dwordx4 v11, s[8:11], s55 offen lds
  s_add_u32 m0, s47, -512
  s_nop 0
  buffer_load_dwordx4 v2, s[4:7], s24 offen offset:512 lds
  s_add_u32 m0, s47, 512
  s_nop 0
  buffer_load_dwordx4 v3, s[4:7], s25 offen offset:512 lds
  s_add_u32 m0, s47, 1536
  s_nop 0
  buffer_load_dwordx4 v2, s[4:7], s26 offen offset:512 lds
  s_add_u32 m0, s47, 2560
  s_nop 0
  buffer_load_dwordx4 v3, s[4:7], s27 offen offset:512 lds
  s_waitcnt lgkmcnt(4)
  v_mfma_f32_32x32x16_bf16 v[48:63], v[24:27], v[160:163], v[48:63]
  ds_read_b64_tr_b16 v[36:37], v8 offset:13824
  ds_read_b64_tr_b16 v[38:39], v8 offset:14208
  v_mfma_f32_4x4x4_16b_bf16 v[16:19], v[160:161], v[160:161], v[16:19]
  s_waitcnt lgkmcnt(4)
  v_mfma_f32_32x32x16_bf16 v[64:79], v[28:31], v[160:163], v[64:79]
  ds_read_b64_tr_b16 v[40:41], v8 offset:13856
  ds_read_b64_tr_b16 v[42:43], v8 offset:14240
  v_mfma_f32_16x16x32_bf16 v[100:103], v[96:99], v[160:163], v[100:103]
  s_waitcnt lgkmcnt(4)
  v_mfma_f32_32x32x16_bf16 v[80:95], v[32:35], v[160:163], v[80:95]
  ds_read_b64_tr_b16 v[44:45], v8 offset:13888
  ds_read_b64_tr_b16 v[46:47], v8 offset:14272
  v_mfma_f32_4x4x4_16b_bf16 v[16:19], v[162:163], v[162:163], v[16:19]
  s_waitcnt lgkmcnt(4)
  v_mfma_f32_32x32x16_bf16 v[48:63], v[36:39], v[164:167], v[48:63]
  ds_read_b64_tr_b16 v[24:25], v8 offset:15360
  ds_read_b64_tr_b16 v[26:27], v8 offset:15744
  v_mfma_f32_4x4x4_16b_bf16 v[16:19], v[164:165], v[164:165], v[16:19]
  s_waitcnt lgkmcnt(4)
  v_mfma_f32_32x32x16_bf16 v[64:79], v[40:43], v[164:167], v[64:79]
  ds_read_b64_tr_b16 v[28:29], v8 offset:15392
  ds_read_b64_tr_b16 v[30:31], v8 offset:15776
  v_mfma_f32_16x16x32_bf16 v[100:103], v[96:99], v[164:167], v[100:103]
  s_waitcnt lgkmcnt(4)
  v_mfma_f32_32x32x16_bf16 v[80:95], v[44:47], v[164:167], v[80:95]
  ds_read_b64_tr_b16 v[32:33], v8 offset:15424
  ds_read_b64_tr_b16 v[34:35], v8 offset:15808
  v_mfma_f32_4x4x4_16b_bf16 v[16:19], v[166:167], v[166:167], v[16:19]
  s_waitcnt vmcnt(7)
  ds_read_b128 v[176:179], v4 offset:4096
  ds_read_b128 v[180:183], v5 offset:4096
  ds_read_b128 v[184:187], v6 offset:4096
  ds_read_b128 v[188:191], v7 offset:4096
  s_waitcnt lgkmcnt(8)
  v_mfma_f32_32x32x16_bf16 v[48:63], v[24:27], v[168:171], v[48:63]
  ds_read_b64_tr_b16 v[36:37], v8 offset:16896
  ds_read_b64_tr_b16 v[38:39], v8 offset:17280
  v_mfma_f32_4x4x4_16b_bf16 v[16:19], v[168:169], v[168:169], v[16:19]
  s_waitcnt lgkmcnt(8)
  v_mfma_f32_32x32x16_bf16 v[64:79], v[28:31], v[168:171], v[64:79]
  ds_read_b64_tr_b16 v[40:41], v8 offset:16928
  ds_read_b64_tr_b16 v[42:43], v8 offset:17312
  v_mfma_f32_16x16x32_bf16 v[100:103], v[96:99], v[168:171], v[100:103]
  s_waitcnt lgkmcnt(8)
  v_mfma_f32_32x32x16_bf16 v[80:95], v[32:35], v[168:171], v[80:95]
  ds_read_b64_tr_b16 v[44:45], v8 offset:16960
  ds_read_b64_tr_b16 v[46:47], v8 offset:17344
  v_mfma_f32_4x4x4_16b_bf16 v[16:19], v[170:171], v[170:171], v[16:19]
  s_waitcnt lgkmcnt(4)
  v_mfma_f32_32x32x16_bf16 v[48:63], v[36:39], v[172:175], v[48:63]
  ds_read_b64_tr_b16 v[24:25], v8 offset:18432
  ds_read_b64_tr_b16 v[26:27], v8 offset:18816
  v_mfma_f32_4x4x4_16b_bf16 v[16:19], v[172:173], v[172:173], v[16:19]
  s_add_u32 m0, s47, 3456
  s_nop 0
  buffer_load_dwordx4 v2, s[4:7], s24 offen offset:640 lds
  s_waitcnt lgkmcnt(4)
  v_mfma_f32_32x32x16_bf16 v[64:79], v[40:43], v[172:175], v[64:79]
  ds_read_b64_tr_b16 v[28:29], v8 offset:18464
  ds_read_b64_tr_b16 v[30:31], v8 offset:18848
  v_mfma_f32_16x16x32_bf16 v[100:103], v[96:99], v[172:175], v[100:103]
  s_add_u32 m0, s47, 4480
  s_nop 0
  buffer_load_dwordx4 v3, s[4:7], s25 offen offset:640 lds
  s_waitcnt lgkmcnt(4)
  v_mfma_f32_32x32x16_bf16 v[80:95], v[44:47], v[172:175], v[80:95]
  ds_read_b64_tr_b16 v[32:33], v8 offset:18496
  ds_read_b64_tr_b16 v[34:35], v8 offset:18880
  v_mfma_f32_4x4x4_16b_bf16 v[16:19], v[174:175], v[174:175], v[16:19]
  s_add_u32 m0, s47, 5504
  s_nop 0
  buffer_load_dwordx4 v2, s[4:7], s26 offen offset:640 lds
  s_add_u32 m0, s47, 6528
  s_nop 0
  buffer_load_dwordx4 v3, s[4:7], s27 offen offset:640 lds
  s_waitcnt lgkmcnt(4)
  v_mfma_f32_32x32x16_bf16 v[48:63], v[24:27], v[176:179], v[48:63]
  ds_read_b64_tr_b16 v[36:37], v8 offset:19968
  ds_read_b64_tr_b16 v[38:39], v8 offset:20352
  v_mfma_f32_4x4x4_16b_bf16 v[16:19], v[176:177], v[176:177], v[16:19]
  s_waitcnt lgkmcnt(4)
  v_mfma_f32_32x32x16_bf16 v[64:79], v[28:31], v[176:179], v[64:79]
  ds_read_b64_tr_b16 v[40:41], v8 offset:20000
  ds_read_b64_tr_b16 v[42:43], v8 offset:20384
  v_mfma_f32_16x16x32_bf16 v[100:103], v[96:99], v[176:179], v[100:103]
  s_waitcnt lgkmcnt(4)
  v_mfma_f32_32x32x16_bf16 v[80:95], v[32:35], v[176:179], v[80:95]
  ds_read_b64_tr_b16 v[44:45], v8 offset:20032
  ds_read_b64_tr_b16 v[46:47], v8 offset:20416
  v_mfma_f32_4x4x4_16b_bf16 v[16:19], v[178:179], v[178:179], v[16:19]
  s_waitcnt lgkmcnt(4)
  v_mfma_f32_32x32x16_bf16 v[48:63], v[36:39], v[180:183], v[48:63]
  ds_read_b64_tr_b16 v[24:25], v8 offset:21504
  ds_read_b64_tr_b16 v[26:27], v8 offset:21888
  v_mfma_f32_4x4x4_16b_bf16 v[16:19], v[180:181], v[180:181], v[16:19]
  s_waitcnt lgkmcnt(4)
  v_mfma_f32_32x32x16_bf16 v[64:79], v[40:43], v[180:183], v[64:79]
  ds_read_b64_tr_b16 v[28:29], v8 offset:21536
  ds_read_b64_tr_b16 v[30:31], v8 offset:21920
  v_mfma_f32_16x16x32_bf16 v[100:103], v[96:99], v[180:183], v[100:103]
  s_waitcnt lgkmcnt(4)
  v_mfma_f32_32x32x16_bf16 v[80:95], v[44:47], v[180:183], v[80:95]
  ds_read_b64_tr_b16 v[32:33], v8 offset:21568
  ds_read_b64_tr_b16 v[34:35], v8 offset:21952
  v_mfma_f32_4x4x4_16b_bf16 v[16:19], v[182:183], v[182:183], v[16:19]
  ds_read_b64_tr_b16 v[116:117], v1 offset:12288
  ds_read_b64_tr_b16 v[118:119], v1 offset:12672
  ds_read_b64_tr_b16 v[120:121], v1 offset:12320
  ds_read_b64_tr_b16 v[122:123], v1 offset:12704
  ds_read_b64_tr_b16 v[124:125], v1 offset:12352
  ds_read_b64_tr_b16 v[126:127], v1 offset:12736
  s_waitcnt vmcnt(4)
  ds_read_b128 v[192:195], v4 offset:0
  ds_read_b128 v[196:199], v5 offset:0
  ds_read_b128 v[200:203], v6 offset:0
  ds_read_b128 v[204:207], v7 offset:0
  s_waitcnt lgkmcnt(14)
  v_mfma_f32_32x32x16_bf16 v[48:63], v[24:27], v[184:187], v[48:63]
  ds_read_b64_tr_b16 v[36:37], v8 offset:23040
  ds_read_b64_tr_b16 v[38:39], v8 offset:23424
  v_mfma_f32_4x4x4_16b_bf16 v[16:19], v[184:185], v[184:185], v[16:19]
  s_waitcnt lgkmcnt(14)
  v_mfma_f32_32x32x16_bf16 v[64:79], v[28:31], v[184:187], v[64:79]
  ds_read_b64_tr_b16 v[40:41], v8 offset:23072
  ds_read_b64_tr_b16 v[42:43], v8 offset:23456
  v_mfma_f32_16x16x32_bf16 v[100:103], v[96:99], v[184:187], v[100:103]
  s_waitcnt lgkmcnt(14)
  v_mfma_f32_32x32x16_bf16 v[80:95], v[32:35], v[184:187], v[80:95]
  ds_read_b64_tr_b16 v[44:45], v8 offset:23104
  ds_read_b64_tr_b16 v[46:47], v8 offset:23488
  v_mfma_f32_4x4x4_16b_bf16 v[16:19], v[186:187], v[186:187], v[16:19]
  s_waitcnt lgkmcnt(10)
  v_mfma_f32_16x16x32_bf16 v[104:107], v[96:99], v[116:119], v[104:107]
  v_mfma_f32_16x16x32_bf16 v[108:111], v[96:99], v[120:123], v[108:111]
  v_mfma_f32_16x16x32_bf16 v[112:115], v[96:99], v[124:127], v[112:115]
  s_waitcnt lgkmcnt(0)
  s_barrier
  v_mfma_f32_32x32x16_bf16 v[48:63], v[36:39], v[188:191], v[48:63]
  ds_read_b64_tr_b16 v[24:25], v8 offset:24576
  ds_read_b64_tr_b16 v[26:27], v8 offset:24960
  v_mfma_f32_4x4x4_16b_bf16 v[16:19], v[188:189], v[188:189], v[16:19]
  s_mul_i32 s52, s43, 0
  s_add_u32 s52, s52, s42
  s_add_u32 s53, s52, s44
  s_cmp_eq_u32 s46, 0
  s_mov_b32 s56, 83968
  s_cselect_b32 s56, s56, 120960
  s_add_u32 s56, s56, s45
  s_add_u32 m0, s56, 0
  s_nop 0
  buffer_load_dwordx4 v12, s[12:15], s52 offen lds
  v_mfma_f32_32x32x16_bf16 v[64:79], v[40:43], v[188:191], v[64:79]
  ds_read_b64_tr_b16 v[28:29], v8 offset:24608
  ds_read_b64_tr_b16 v[30:31], v8 offset:24992
  v_mfma_f32_16x16x32_bf16 v[100:103], v[96:99], v[188:191], v[100:103]
  s_add_u32 m0, s56, 1024
  s_nop 0
  buffer_load_dwordx4 v12, s[12:15], s53 offen lds
  v_mfma_f32_32x32x16_bf16 v[80:95], v[44:47], v[188:191], v[80:95]
  ds_read_b64_tr_b16 v[32:33], v8 offset:24640
  ds_read_b64_tr_b16 v[34:35], v8 offset:25024
  v_mfma_f32_4x4x4_16b_bf16 v[16:19], v[190:191], v[190:191], v[16:19]
  s_add_u32 m0, s47, -768
  s_nop 0
  buffer_load_dwordx4 v2, s[4:7], s24 offen offset:768 lds
  s_add_u32 m0, s47, 256
  s_nop 0
  buffer_load_dwordx4 v3, s[4:7], s25 offen offset:768 lds
  s_add_u32 m0, s47, 1280
  s_nop 0
  buffer_load_dwordx4 v2, s[4:7], s26 offen offset:768 lds
  s_add_u32 m0, s47, 2304
  s_nop 0
  buffer_load_dwordx4 v3, s[4:7], s27 offen offset:768 lds
  s_waitcnt lgkmcnt(4)
  v_mfma_f32_32x32x16_bf16 v[48:63], v[24:27], v[192:195], v[48:63]
  ds_read_b64_tr_b16 v[36:37], v8 offset:26112
  ds_read_b64_tr_b16 v[38:39], v8 offset:26496
  v_mfma_f32_4x4x4_16b_bf16 v[16:19], v[192:193], v[192:193], v[16:19]
  s_waitcnt lgkmcnt(4)
  v_mfma_f32_32x32x16_bf16 v[64:79], v[28:31], v[192:195], v[64:79]
  ds_read_b64_tr_b16 v[40:41], v8 offset:26144
  ds_read_b64_tr_b16 v[42:43], v8 offset:26528
  v_mfma_f32_16x16x32_bf16 v[100:103], v[96:99], v[192:195], v[100:103]
  s_waitcnt lgkmcnt(4)
  v_mfma_f32_32x32x16_bf16 v[80:95], v[32:35], v[192:195], v[80:95]
  ds_read_b64_tr_b16 v[44:45], v8 offset:26176
  ds_read_b64_tr_b16 v[46:47], v8 offset:26560
  v_mfma_f32_4x4x4_16b_bf16 v[16:19], v[194:195], v[194:195], v[16:19]
  s_waitcnt lgkmcnt(4)
  v_mfma_f32_32x32x16_bf16 v[48:63], v[36:39], v[196:199], v[48:63]
  ds_read_b64_tr_b16 v[24:25], v8 offset:27648
  ds_read_b64_tr_b16 v[26:27], v8 offset:28032
  v_mfma_f32_4x4x4_16b_bf16 v[16:19], v[196:197], v[196:197], v[16:19]
  s_waitcnt lgkmcnt(4)
  v_mfma_f32_32x32x16_bf16 v[64:79], v[40:43], v[196:199], v[64:79]
  ds_read_b64_tr_b16 v[28:29], v8 offset:27680
  ds_read_b64_tr_b16 v[30:31], v8 offset:28064
  v_mfma_f32_16x16x32_bf16 v[100:103], v[96:99], v[196:199], v[100:103]
  s_waitcnt lgkmcnt(4)
  v_mfma_f32_32x32x16_bf16 v[80:95], v[44:47], v[196:199], v[80:95]
  ds_read_b64_tr_b16 v[32:33], v8 offset:27712
  ds_read_b64_tr_b16 v[34:35], v8 offset:28096
  v_mfma_f32_4x4x4_16b_bf16 v[16:19], v[198:199], v[198:199], v[16:19]
  s_waitcnt vmcnt(6)
  ds_read_b128 v[208:211], v4 offset:4096
  ds_read_b128 v[212:215], v5 offset:4096
  ds_read_b128 v[216:219], v6 offset:4096
  ds_read_b128 v[220:223], v7 offset:4096
  s_waitcnt lgkmcnt(8)
  v_mfma_f32_32x32x16_bf16 v[48:63], v[24:27], v[200:203], v[48:63]
  ds_read_b64_tr_b16 v[36:37], v8 offset:29184
  ds_read_b64_tr_b16 v[38:39], v8 offset:29568
  v_mfma_f32_4x4x4_16b_bf16 v[16:19], v[200:201], v[200:201], v[16:19]
  s_waitcnt lgkmcnt(8)
  v_mfma_f32_32x32x16_bf16 v[64:79], v[28:31], v[200:203], v[64:79]
  ds_read_b64_tr_b16 v[40:41], v8 offset:29216
  ds_read_b64_tr_b16 v[42:43], v8 offset:29600
  v_mfma_f32_16x16x32_bf16 v[100:103], v[96:99], v[200:203], v[100:103]
  s_waitcnt lgkmcnt(8)
  v_mfma_f32_32x32x16_bf16 v[80:95], v[32:35], v[200:203], v[80:95]
  ds_read_b64_tr_b16 v[44:45], v8 offset:29248
  ds_read_b64_tr_b16 v[46:47], v8 offset:29632
  v_mfma_f32_4x4x4_16b_bf16 v[16:19], v[202:203], v[202:203], v[16:19]
  s_waitcnt lgkmcnt(4)
  v_mfma_f32_32x32x16_bf16 v[48:63], v[36:39], v[204:207], v[48:63]
  ds_read_b64_tr_b16 v[24:25], v8 offset:30720
  ds_read_b64_tr_b16 v[26:27], v8 offset:31104
  v_mfma_f32_4x4x4_16b_bf16 v[16:19], v[204:205], v[204:205], v[16:19]
  s_add_u32 m0, s47, 3200
  s_nop 0
  buffer_load_dwordx4 v2, s[4:7], s24 offen offset:896 lds
  s_waitcnt lgkmcnt(4)
  v_mfma_f32_32x32x16_bf16 v[64:79], v[40:43], v[204:207], v[64:79]
  ds_read_b64_tr_b16 v[28:29], v8 offset:30752
  ds_read_b64_tr_b16 v[30:31], v8 offset:31136
  v_mfma_f32_16x16x32_bf16 v[100:103], v[96:99], v[204:207], v[100:103]
  s_add_u32 m0, s47, 4224
  s_nop 0
  buffer_load_dwordx4 v3, s[4:7], s25 offen offset:896 lds
  s_waitcnt lgkmcnt(4)
  v_mfma_f32_32x32x16_bf16 v[80:95], v[44:47], v[204:207], v[80:95]
  ds_read_b64_tr_b16 v[32:33], v8 offset:30784
  ds_read_b64_tr_b16 v[34:35], v8 offset:31168
  v_mfma_f32_4x4x4_16b_bf16 v[16:19], v[206:207], v[206:207], v[16:19]
  s_add_u32 m0, s47, 5248
  s_nop 0
  buffer_load_dwordx4 v2, s[4:7], s26 offen offset:896 lds
  s_add_u32 m0, s47, 6272
  s_nop 0
  buffer_load_dwordx4 v3, s[4:7], s27 offen offset:896 lds
  s_waitcnt lgkmcnt(4)
  v_mfma_f32_32x32x16_bf16 v[48:63], v[24:27], v[208:211], v[48:63]
  ds_read_b64_tr_b16 v[36:37], v8 offset:32256
  ds_read_b64_tr_b16 v[38:39], v8 offset:32640
  v_mfma_f32_4x4x4_16b_bf16 v[16:19], v[208:209], v[208:209], v[16:19]
  s_waitcnt lgkmcnt(4)
  v_mfma_f32_32x32x16_bf16 v[64:79], v[28:31], v[208:211], v[64:79]
  ds_read_b64_tr_b16 v[40:41], v8 offset:32288
  ds_read_b64_tr_b16 v[42:43], v8 offset:32672
  v_mfma_f32_16x16x32_bf16 v[100:103], v[96:99], v[208:211], v[100:103]
  s_waitcnt lgkmcnt(4)
  v_mfma_f32_32x32x16_bf16 v[80:95], v[32:35], v[208:211], v[80:95]
  ds_read_b64_tr_b16 v[44:45], v8 offset:32320
  ds_read_b64_tr_b16 v[46:47], v8 offset:32704
  v_mfma_f32_4x4x4_16b_bf16 v[16:19], v[210:211], v[210:211], v[16:19]
  s_waitcnt lgkmcnt(4)
  v_mfma_f32_32x32x16_bf16 v[48:63], v[36:39], v[212:215], v[48:63]
  ds_read_b64_tr_b16 v[24:25], v8 offset:33792
  ds_read_b64_tr_b16 v[26:27], v8 offset:34176
  v_mfma_f32_4x4x4_16b_bf16 v[16:19], v[212:213], v[212:213], v[16:19]
  s_waitcnt lgkmcnt(4)
  v_mfma_f32_32x32x16_bf16 v[64:79], v[40:43], v[212:215], v[64:79]
  ds_read_b64_tr_b16 v[28:29], v8 offset:33824
  ds_read_b64_tr_b16 v[30:31], v8 offset:34208
  v_mfma_f32_16x16x32_bf16 v[100:103], v[96:99], v[212:215], v[100:103]
  s_waitcnt lgkmcnt(4)
  v_mfma_f32_32x32x16_bf16 v[80:95], v[44:47], v[212:215], v[80:95]
  ds_read_b64_tr_b16 v[32:33], v8 offset:33856
  ds_read_b64_tr_b16 v[34:35], v8 offset:34240
  v_mfma_f32_4x4x4_16b_bf16 v[16:19], v[214:215], v[214:215], v[16:19]
  ds_read_b64_tr_b16 v[116:117], v1 offset:24576
  ds_read_b64_tr_b16 v[118:119], v1 offset:24960
  ds_read_b64_tr_b16 v[120:121], v1 offset:24608
  ds_read_b64_tr_b16 v[122:123], v1 offset:24992
  ds_read_b64_tr_b16 v[124:125], v1 offset:24640
  ds_read_b64_tr_b16 v[126:127], v1 offset:25024
  s_waitcnt vmcnt(4)
  ds_read_b128 v[224:227], v4 offset:0
  ds_read_b128 v[228:231], v5 offset:0
  ds_read_b128 v[232:235], v6 offset:0
  ds_read_b128 v[236:239], v7 offset:0
  s_waitcnt lgkmcnt(14)
  v_mfma_f32_32x32x16_bf16 v[48:63], v[24:27], v[216:219], v[48:63]
  ds_read_b64_tr_b16 v[36:37], v8 offset:35328
  ds_read_b64_tr_b16 v[38:39], v8 offset:35712
  v_mfma_f32_4x4x4_16b_bf16 v[16:19], v[216:217], v[216:217], v[16:19]
  s_waitcnt lgkmcnt(14)
  v_mfma_f32_32x32x16_bf16 v[64:79], v[28:31], v[216:219], v[64:79]
  ds_read_b64_tr_b16 v[40:41], v8 offset:35360
  ds_read_b64_tr_b16 v[42:43], v8 offset:35744
  v_mfma_f32_16x16x32_bf16 v[100:103], v[96:99], v[216:219], v[100:103]
  s_waitcnt lgkmcnt(14)
  v_mfma_f32_32x32x16_bf16 v[80:95], v[32:35], v[216:219], v[80:95]
  ds_read_b64_tr_b16 v[44:45], v8 offset:35392
  ds_read_b64_tr_b16 v[46:47], v8 offset:35776
  v_mfma_f32_4x4x4_16b_bf16 v[16:19], v[218:219], v[218:219], v[16:19]
  s_waitcnt lgkmcnt(10)
  v_mfma_f32_16x16x32_bf16 v[104:107], v[96:99], v[116:119], v[104:107]
  v_mfma_f32_16x16x32_bf16 v[108:111], v[96:99], v[120:123], v[108:111]
  v_mfma_f32_16x16x32_bf16 v[112:115], v[96:99], v[124:127], v[112:115]
  s_waitcnt lgkmcnt(0)
  s_barrier
  v_mfma_f32_32x32x16_bf16 v[48:63], v[36:39], v[220:223], v[48:63]
  ds_read_b64_tr_b16 v[24:25], v8 offset:0
  ds_read_b64_tr_b16 v[26:27], v8 offset:384
  v_mfma_f32_4x4x4_16b_bf16 v[16:19], v[220:221], v[220:221], v[16:19]
  s_mul_i32 s52, s43, 1
  s_add_u32 s52, s52, s42
  s_add_u32 s53, s52, s44
  s_cmp_eq_u32 s46, 0
  s_mov_b32 s56, 96256
  s_cselect_b32 s56, s56, 133248
  s_add_u32 s56, s56, s45
  s_add_u32 m0, s56, 0
  s_nop 0
  buffer_load_dwordx4 v12, s[12:15], s52 offen lds
  v_mfma_f32_32x32x16_bf16 v[64:79], v[40:43], v[220:223], v[64:79]
  ds_read_b64_tr_b16 v[28:29], v8 offset:32
  ds_read_b64_tr_b16 v[30:31], v8 offset:416
  v_mfma_f32_16x16x32_bf16 v[100:103], v[96:99], v[220:223], v[100:103]
  s_add_u32 m0, s56, 1024
  s_nop 0
  buffer_load_dwordx4 v12, s[12:15], s53 offen lds
  v_mfma_f32_32x32x16_bf16 v[80:95], v[44:47], v[220:223], v[80:95]
  ds_read_b64_tr_b16 v[32:33], v8 offset:64
  ds_read_b64_tr_b16 v[34:35], v8 offset:448
  v_mfma_f32_4x4x4_16b_bf16 v[16:19], v[222:223], v[222:223], v[16:19]
  s_waitcnt lgkmcnt(4)
  v_mfma_f32_32x32x16_bf16 v[48:63], v[24:27], v[224:227], v[48:63]
  ds_read_b64_tr_b16 v[36:37], v8 offset:1536
  ds_read_b64_tr_b16 v[38:39], v8 offset:1920
  v_mfma_f32_4x4x4_16b_bf16 v[16:19], v[224:225], v[224:225], v[16:19]
  s_waitcnt lgkmcnt(4)
  v_mfma_f32_32x32x16_bf16 v[64:79], v[28:31], v[224:227], v[64:79]
  ds_read_b64_tr_b16 v[40:41], v8 offset:1568
  ds_read_b64_tr_b16 v[42:43], v8 offset:1952
  v_mfma_f32_16x16x32_bf16 v[100:103], v[96:99], v[224:227], v[100:103]
  s_waitcnt lgkmcnt(4)
  v_mfma_f32_32x32x16_bf16 v[80:95], v[32:35], v[224:227], v[80:95]
  ds_read_b64_tr_b16 v[44:45], v8 offset:1600
  ds_read_b64_tr_b16 v[46:47], v8 offset:1984
  v_mfma_f32_4x4x4_16b_bf16 v[16:19], v[226:227], v[226:227], v[16:19]
  s_waitcnt vmcnt(2)
  ds_read_b128 v[240:243], v4 offset:4096
  ds_read_b128 v[244:247], v5 offset:4096
  ds_read_b128 v[248:251], v6 offset:4096
  ds_read_b128 v[252:255], v7 offset:4096
  s_waitcnt lgkmcnt(8)
  v_mfma_f32_32x32x16_bf16 v[48:63], v[36:39], v[228:231], v[48:63]
  ds_read_b64_tr_b16 v[24:25], v8 offset:3072
  ds_read_b64_tr_b16 v[26:27], v8 offset:3456
  v_mfma_f32_4x4x4_16b_bf16 v[16:19], v[228:229], v[228:229], v[16:19]
  s_waitcnt lgkmcnt(8)
  v_mfma_f32_32x32x16_bf16 v[64:79], v[40:43], v[228:231], v[64:79]
  ds_read_b64_tr_b16 v[28:29], v8 offset:3104
  ds_read_b64_tr_b16 v[30:31], v8 offset:3488
  v_mfma_f32_16x16x32_bf16 v[100:103], v[96:99], v[228:231], v[100:103]
  s_waitcnt lgkmcnt(8)
  v_mfma_f32_32x32x16_bf16 v[80:95], v[44:47], v[228:231], v[80:95]
  ds_read_b64_tr_b16 v[32:33], v8 offset:3136
  ds_read_b64_tr_b16 v[34:35], v8 offset:3520
  v_mfma_f32_4x4x4_16b_bf16 v[16:19], v[230:231], v[230:231], v[16:19]
  s_waitcnt lgkmcnt(4)
  v_mfma_f32_32x32x16_bf16 v[48:63], v[24:27], v[232:235], v[48:63]
  ds_read_b64_tr_b16 v[36:37], v8 offset:4608
  ds_read_b64_tr_b16 v[38:39], v8 offset:4992
  v_mfma_f32_4x4x4_16b_bf16 v[16:19], v[232:233], v[232:233], v[16:19]
  v_mfma_f32_16x16x32_bf16 v[100:103], v[96:99], v[232:235], v[100:103]
  s_waitcnt lgkmcnt(4)
  v_mfma_f32_32x32x16_bf16 v[64:79], v[28:31], v[232:235], v[64:79]
  ds_read_b64_tr_b16 v[40:41], v8 offset:4640
  ds_read_b64_tr_b16 v[42:43], v8 offset:5024
  v_mfma_f32_4x4x4_16b_bf16 v[16:19], v[234:235], v[234:235], v[16:19]
  s_nop 1
  v_mfma_f32_4x4x4_16b_bf16 v[16:19], v[236:237], v[236:237], v[16:19]
  s_waitcnt lgkmcnt(4)
  v_mfma_f32_32x32x16_bf16 v[80:95], v[32:35], v[232:235], v[80:95]
  ds_read_b64_tr_b16 v[44:45], v8 offset:4672
  ds_read_b64_tr_b16 v[46:47], v8 offset:5056
  v_mfma_f32_16x16x32_bf16 v[100:103], v[96:99], v[236:239], v[100:103]
  v_mfma_f32_4x4x4_16b_bf16 v[16:19], v[238:239], v[238:239], v[16:19]
  s_waitcnt lgkmcnt(4)
  v_mfma_f32_32x32x16_bf16 v[48:63], v[36:39], v[236:239], v[48:63]
  ds_read_b64_tr_b16 v[24:25], v8 offset:6144
  ds_read_b64_tr_b16 v[26:27], v8 offset:6528
  v_mfma_f32_4x4x4_16b_bf16 v[16:19], v[240:241], v[240:241], v[16:19]
  v_mfma_f32_16x16x32_bf16 v[100:103], v[96:99], v[240:243], v[100:103]
  s_waitcnt lgkmcnt(4)
  v_mfma_f32_32x32x16_bf16 v[64:79], v[40:43], v[236:239], v[64:79]
  ds_read_b64_tr_b16 v[28:29], v8 offset:6176
  ds_read_b64_tr_b16 v[30:31], v8 offset:6560
  v_mfma_f32_4x4x4_16b_bf16 v[16:19], v[242:243], v[242:243], v[16:19]
  s_nop 1
  v_mfma_f32_4x4x4_16b_bf16 v[16:19], v[244:245], v[244:245], v[16:19]
  s_waitcnt lgkmcnt(4)
  v_mfma_f32_32x32x16_bf16 v[80:95], v[44:47], v[236:239], v[80:95]
  ds_read_b64_tr_b16 v[32:33], v8 offset:6208
  ds_read_b64_tr_b16 v[34:35], v8 offset:6592
  v_mfma_f32_16x16x32_bf16 v[100:103], v[96:99], v[244:247], v[100:103]
  v_mfma_f32_4x4x4_16b_bf16 v[16:19], v[246:247], v[246:247], v[16:19]
  s_waitcnt lgkmcnt(4)
  v_mfma_f32_32x32x16_bf16 v[48:63], v[24:27], v[240:243], v[48:63]
  ds_read_b64_tr_b16 v[36:37], v8 offset:7680
  ds_read_b64_tr_b16 v[38:39], v8 offset:8064
  v_mfma_f32_4x4x4_16b_bf16 v[16:19], v[248:249], v[248:249], v[16:19]
  v_mfma_f32_16x16x32_bf16 v[100:103], v[96:99], v[248:251], v[100:103]
  s_waitcnt lgkmcnt(4)
  v_mfma_f32_32x32x16_bf16 v[64:79], v[28:31], v[240:243], v[64:79]
  ds_read_b64_tr_b16 v[40:41], v8 offset:7712
  ds_read_b64_tr_b16 v[42:43], v8 offset:8096
  v_mfma_f32_4x4x4_16b_bf16 v[16:19], v[250:251], v[250:251], v[16:19]
  s_nop 1
  v_mfma_f32_4x4x4_16b_bf16 v[16:19], v[252:253], v[252:253], v[16:19]
  s_waitcnt lgkmcnt(4)
  v_mfma_f32_32x32x16_bf16 v[80:95], v[32:35], v[240:243], v[80:95]
  ds_read_b64_tr_b16 v[44:45], v8 offset:7744
  ds_read_b64_tr_b16 v[46:47], v8 offset:8128
  v_mfma_f32_16x16x32_bf16 v[100:103], v[96:99], v[252:255], v[100:103]
  v_mfma_f32_4x4x4_16b_bf16 v[16:19], v[254:255], v[254:255], v[16:19]
  s_waitcnt lgkmcnt(4)
  v_mfma_f32_32x32x16_bf16 v[48:63], v[36:39], v[244:247], v[48:63]
  ds_read_b64_tr_b16 v[24:25], v8 offset:9216
  ds_read_b64_tr_b16 v[26:27], v8 offset:9600
  s_nop 0
  v_mov_b32 v20, v19
  v_and_b32 v19, 15, v0
  v_lshlrev_b32 v19, 2, v19
  ds_bpermute_b32 v2, v19, v100
  ds_bpermute_b32 v3, v19, v101
  s_waitcnt lgkmcnt(6)
  v_mfma_f32_32x32x16_bf16 v[64:79], v[40:43], v[244:247], v[64:79]
  ds_read_b64_tr_b16 v[28:29], v8 offset:9248
  ds_read_b64_tr_b16 v[30:31], v8 offset:9632
  v_and_b32 v15, 3, v0
  v_cmp_eq_u32 vcc, 1, v15
  s_nop 1
  v_cndmask_b32 v16, v16, v17, vcc
  v_cmp_eq_u32 vcc, 2, v15
  s_nop 1
  v_cndmask_b32 v16, v16, v18, vcc
  s_waitcnt lgkmcnt(6)
  v_mfma_f32_32x32x16_bf16 v[80:95], v[44:47], v[244:247], v[80:95]
  ds_read_b64_tr_b16 v[32:33], v8 offset:9280
  ds_read_b64_tr_b16 v[34:35], v8 offset:9664
  v_cmp_eq_u32 vcc, 3, v15
  s_nop 1
  v_cndmask_b32 v16, v16, v20, vcc
  v_mov_b32 v17, v16
  s_nop 1
  v_permlane32_swap_b32 v16, v17
  v_add_f32 v16, v16, v17
  ds_read_b64_tr_b16 v[116:117], v1 offset:0
  ds_read_b64_tr_b16 v[118:119], v1 offset:384
  ds_read_b64_tr_b16 v[120:121], v1 offset:32
  ds_read_b64_tr_b16 v[122:123], v1 offset:416
  ds_read_b64_tr_b16 v[124:125], v1 offset:64
  ds_read_b64_tr_b16 v[126:127], v1 offset:448
  s_waitcnt lgkmcnt(12)
  v_mfma_f32_32x32x16_bf16 v[48:63], v[24:27], v[248:251], v[48:63]
  ds_read_b64_tr_b16 v[36:37], v8 offset:10752
  ds_read_b64_tr_b16 v[38:39], v8 offset:11136
  v_and_b32 v19, 16, v0
  v_cmp_ne_u32 vcc, 0, v19
  s_waitcnt lgkmcnt(12)
  s_nop 0
  v_cndmask_b32 v15, v2, v3, vcc
  v_mul_f32 v15, 0x3b000000, v15
  s_waitcnt lgkmcnt(10)
  v_mfma_f32_32x32x16_bf16 v[64:79], v[28:31], v[248:251], v[64:79]
  ds_read_b64_tr_b16 v[40:41], v8 offset:10784
  ds_read_b64_tr_b16 v[42:43], v8 offset:11168
  v_mul_f32 v16, 0x3b000000, v16
  v_fma_f32 v16, -v15, v15, v16
  v_max_f32 v16, 0, v16
  v_cvt_pk_bf16_f32 v16, v16, v16
  v_lshlrev_b32 v16, 16, v16
  s_waitcnt lgkmcnt(10)
  v_mfma_f32_32x32x16_bf16 v[80:95], v[32:35], v[248:251], v[80:95]
  ds_read_b64_tr_b16 v[44:45], v8 offset:10816
  ds_read_b64_tr_b16 v[46:47], v8 offset:11200
  v_add_f32 v16, 0x3727c5ac, v16
  v_cvt_pk_bf16_f32 v16, v16, v16
  v_lshlrev_b32 v16, 16, v16
  v_sqrt_f32 v16, v16
  s_nop 0
  v_cvt_pk_bf16_f32 v16, v16, v16
  v_lshlrev_b32 v16, 16, v16
  s_waitcnt lgkmcnt(4)
  v_mfma_f32_32x32x16_bf16 v[48:63], v[36:39], v[252:255], v[48:63]
  v_sub_f32 v15, 0, v15
  v_cvt_pk_bf16_f32 v4, v15, v15
  v_mov_b32 v5, v4
  v_mov_b32 v6, v4
  v_mov_b32 v7, v4
  s_waitcnt lgkmcnt(2)
  v_mfma_f32_32x32x16_bf16 v[64:79], v[40:43], v[252:255], v[64:79]
  v_rcp_f32 v18, v16
  v_mul_f32 v17, v16, v16
  v_mul_f32 v15, 0xc0135761, v18
  v_mul_f32 v19, v18, v18
  v_mul_f32 v19, v19, v18
  s_waitcnt lgkmcnt(0)
  v_mfma_f32_32x32x16_bf16 v[80:95], v[44:47], v[252:255], v[80:95]
  v_mul_f32 v16, 0xbdd2d3e8, v19
  v_and_b32 v19, 31, v0
  v_lshlrev_b32 v19, 2, v19
  s_lshl_b32 s54, s20, 7
  v_add_u32 v19, s54, v19
  ds_write_b32 v19, v18 offset:5120
  v_mfma_f32_16x16x32_bf16 v[104:107], v[96:99], v[116:119], v[104:107]
  v_mfma_f32_16x16x32_bf16 v[108:111], v[96:99], v[120:123], v[108:111]
  v_mfma_f32_16x16x32_bf16 v[112:115], v[96:99], v[124:127], v[112:115]
  s_lshr_b32 s59, s20, 2
  s_lshl_b32 s59, s59, 9
  s_and_b32 s56, s20, 3
  s_lshl_b32 s56, s56, 2
  s_add_u32 s59, s59, s56
  v_add_u32 v1, s59, v22
  s_mov_b64 exec, 0xffff
  v_cvt_pk_bf16_f32 v2, v104, v104
  v_lshlrev_b32 v2, 16, v2
  v_sub_f32 v3, v104, v2
  v_cvt_pk_bf16_f32 v104, v104, v3
  ds_write_b32 v1, v104 offset:0
  v_cvt_pk_bf16_f32 v2, v105, v105
  v_lshlrev_b32 v2, 16, v2
  v_sub_f32 v3, v105, v2
  v_cvt_pk_bf16_f32 v105, v105, v3
  ds_write_b32 v1, v105 offset:256
  v_cvt_pk_bf16_f32 v2, v108, v108
  v_lshlrev_b32 v2, 16, v2
  v_sub_f32 v3, v108, v2
  v_cvt_pk_bf16_f32 v108, v108, v3
  ds_write_b32 v1, v108 offset:1024
  v_cvt_pk_bf16_f32 v2, v109, v109
  v_lshlrev_b32 v2, 16, v2
  v_sub_f32 v3, v109, v2
  v_cvt_pk_bf16_f32 v109, v109, v3
  ds_write_b32 v1, v109 offset:1280
  v_cvt_pk_bf16_f32 v2, v112, v112
  v_lshlrev_b32 v2, 16, v2
  v_sub_f32 v3, v112, v2
  v_cvt_pk_bf16_f32 v112, v112, v3
  ds_write_b32 v1, v112 offset:2048
  v_cvt_pk_bf16_f32 v2, v113, v113
  v_lshlrev_b32 v2, 16, v2
  v_sub_f32 v3, v113, v2
  v_cvt_pk_bf16_f32 v113, v113, v3
  ds_write_b32 v1, v113 offset:2304
  s_mov_b64 exec, -1
  v_mov_b32 v40, v96
  v_mov_b32 v41, v96
  v_mov_b32 v42, v96
  v_mov_b32 v43, v96
  s_lshl_b32 s57, s20, 10
  s_lshl_b32 s58, s20, 9
  s_waitcnt vmcnt(0) lgkmcnt(0)
  s_barrier
  s_mul_i32 s52, s43, 2
  s_add_u32 s52, s52, s42
  s_add_u32 s53, s52, s44
  s_cmp_eq_u32 s46, 0
  s_mov_b32 s56, 71680
  s_cselect_b32 s56, s56, 108672
  s_add_u32 s56, s56, s45
  s_add_u32 m0, s56, 0
  s_nop 0
  buffer_load_dwordx4 v12, s[12:15], s52 offen lds
  s_add_u32 m0, s56, 1024
  s_nop 0
  buffer_load_dwordx4 v12, s[12:15], s53 offen lds
  s_mul_i32 s52, s43, 3
  s_add_u32 s52, s52, s42
  s_add_u32 s53, s52, s44
  s_cmp_eq_u32 s46, 0
  s_mov_b32 s56, 6144
  s_cselect_b32 s56, s56, 14336
  s_add_u32 s56, s56, s45
  s_add_u32 m0, s56, 0
  s_nop 0
  buffer_load_dwordx4 v12, s[12:15], s52 offen lds
  s_add_u32 m0, s56, 1024
  s_nop 0
  buffer_load_dwordx4 v12, s[12:15], s53 offen lds
  s_cmp_eq_u32 s23, 0
  s_cbranch_scc0 K1_VARB
  ds_read_b64_tr_b16 v[24:25], v13 offset:12288
  ds_read_b64_tr_b16 v[26:27], v13 offset:12544
  ds_read_b64_tr_b16 v[28:29], v14 offset:12288
  ds_read_b64_tr_b16 v[30:31], v14 offset:12544
  s_waitcnt lgkmcnt(2)
  v_mfma_f32_32x32x16_bf16 v[96:111], v[24:27], v[128:131], 0
  ds_read_b128 v[8:11], v22 offset:0
  ds_read_b64_tr_b16 v[32:33], v13 offset:13312
  ds_read_b64_tr_b16 v[34:35], v13 offset:13568
  s_waitcnt lgkmcnt(2)
  v_mfma_f32_32x32x16_bf16 v[48:63], v[8:11], v[4:7], v[48:63]
  v_mfma_f32_32x32x16_bf16 v[112:127], v[128:131], v[28:31], 0
  ds_read_b128 v[8:11], v22 offset:1024
  ds_read_b64_tr_b16 v[36:37], v14 offset:13312
  ds_read_b64_tr_b16 v[38:39], v14 offset:13568
  s_waitcnt lgkmcnt(2)
  v_mfma_f32_32x32x16_bf16 v[64:79], v[8:11], v[4:7], v[64:79]
  v_mfma_f32_32x32x16_bf16 v[96:111], v[32:35], v[132:135], v[96:111]
  ds_read_b128 v[8:11], v22 offset:2048
  ds_read_b64_tr_b16 v[24:25], v13 offset:14336
  ds_read_b64_tr_b16 v[26:27], v13 offset:14592
  s_waitcnt lgkmcnt(2)
  v_mfma_f32_32x32x16_bf16 v[80:95], v[8:11], v[4:7], v[80:95]
  v_mfma_f32_32x32x16_bf16 v[112:127], v[132:135], v[36:39], v[112:127]
  v_mul_f32 v1, v48, v48
  ds_read_b64_tr_b16 v[28:29], v14 offset:14336
  ds_read_b64_tr_b16 v[30:31], v14 offset:14592
  v_mul_f32 v2, v49, v49
  v_mul_f32 v3, v50, v50
  s_waitcnt lgkmcnt(2)
  v_mfma_f32_32x32x16_bf16 v[96:111], v[24:27], v[136:139], v[96:111]
  v_mul_f32 v12, v51, v51
  v_fma_f32 v1, v1, v16, v15
  ds_read_b64_tr_b16 v[32:33], v13 offset:15360
  ds_read_b64_tr_b16 v[34:35], v13 offset:15616
  v_fma_f32 v2, v2, v16, v15
  s_waitcnt lgkmcnt(2)
  v_mfma_f32_32x32x16_bf16 v[112:127], v[136:139], v[28:31], v[112:127]
  v_fma_f32 v3, v3, v16, v15
  v_fma_f32 v12, v12, v16, v15
  ds_read_b64_tr_b16 v[36:37], v14 offset:15360
  ds_read_b64_tr_b16 v[38:39], v14 offset:15616
  v_mul_f32 v1, v1, v48
  s_mov_b32 s62, 1835008
  s_mov_b32 s63, 0x20000
  s_mov_b32 s98, 0x80000
  s_mov_b32 s99, 0x20000
  s_lshl_b32 s59, s2, 3
  s_add_u32 s59, s59, s20
  s_lshl_b32 s59, s59, 10
  buffer_load_dwordx4 v[44:47], v22, s[60:63], s59 offen
  buffer_load_dwordx4 v[44:47], v22, s[96:99], s59 offen
  v_mul_f32 v2, v2, v49
  v_mul_f32 v3, v3, v50
  s_waitcnt lgkmcnt(2)
  v_mfma_f32_32x32x16_bf16 v[96:111], v[32:35], v[140:143], v[96:111]
  v_mul_f32 v12, v12, v51
  ds_read_b64_tr_b16 v[24:25], v13 offset:16384
  ds_read_b64_tr_b16 v[26:27], v13 offset:16640
  v_exp_f32 v1, v1
  v_exp_f32 v2, v2
  s_waitcnt lgkmcnt(2)
  v_mfma_f32_32x32x16_bf16 v[112:127], v[140:143], v[36:39], v[112:127]
  v_exp_f32 v3, v3
  v_exp_f32 v12, v12
  ds_read_b64_tr_b16 v[28:29], v14 offset:16384
  ds_read_b64_tr_b16 v[30:31], v14 offset:16640
  v_mul_f32 v48, v48, v56
  s_cmp_ge_u32 s20, 4
  s_cbranch_scc1 K1_TCB0
  s_getpc_b64 s[52:53]
K1_TCB0P:
  s_sub_u32 s52, s52, K1_TCB0P-k1_kernel
  s_subb_u32 s53, s53, 0
  s_lshl_b32 s56, s20, 13
  s_add_u32 s56, s56, 16384
  v_lshl_add_u32 v19, v0, 7, s56
  v_min_u32 v19, CODE_END-k1_kernel-4, v19
  global_load_dword v47, v19, s[52:53]
K1_TCB0:
  v_mul_f32 v49, v49, v57
  v_mul_f32 v50, v50, v58
  s_waitcnt lgkmcnt(2)
  v_mfma_f32_32x32x16_bf16 v[96:111], v[24:27], v[144:147], v[96:111]
  v_mul_f32 v51, v51, v59
  ds_read_b64_tr_b16 v[32:33], v13 offset:17408
  ds_read_b64_tr_b16 v[34:35], v13 offset:17664
  v_fma_f32 v1, v1, v17, v17
  v_fma_f32 v2, v2, v17, v17
  s_waitcnt lgkmcnt(2)
  v_mfma_f32_32x32x16_bf16 v[112:127], v[144:147], v[28:31], v[112:127]
  v_fma_f32 v3, v3, v17, v17
  ds_read_b64_tr_b16 v[36:37], v14 offset:17408
  ds_read_b64_tr_b16 v[38:39], v14 offset:17664
  v_fma_f32 v12, v12, v17, v17
  v_rcp_f32 v1, v1
  s_waitcnt lgkmcnt(2)
  v_mfma_f32_32x32x16_bf16 v[96:111], v[32:35], v[148:151], v[96:111]
  v_rcp_f32 v2, v2
  ds_read_b64_tr_b16 v[24:25], v13 offset:18432
  ds_read_b64_tr_b16 v[26:27], v13 offset:18688
  v_rcp_f32 v3, v3
  v_rcp_f32 v12, v12
  s_waitcnt lgkmcnt(2)
  v_mfma_f32_32x32x16_bf16 v[112:127], v[148:151], v[36:39], v[112:127]
  v_mul_f32 v48, v48, v1
  v_mul_f32 v49, v49, v2
  ds_read_b64_tr_b16 v[28:29], v14 offset:18432
  ds_read_b64_tr_b16 v[30:31], v14 offset:18688
  v_mul_f32 v50, v50, v3
  v_add_u32 v19, s57, v13
  ds_read_b64_tr_b16 v[136:137], v19 offset:12288
  ds_read_b64_tr_b16 v[138:139], v19 offset:12544
  v_add_u32 v20, s57, v14
  ds_read_b64_tr_b16 v[140:141], v20 offset:12288
  ds_read_b64_tr_b16 v[142:143], v20 offset:12544
  v_mul_f32 v51, v51, v12
  v_cvt_pk_bf16_f32 v56, v48, v49
  s_waitcnt lgkmcnt(6)
  v_mfma_f32_32x32x16_bf16 v[96:111], v[24:27], v[152:155], v[96:111]
  v_cvt_pk_bf16_f32 v57, v50, v51
  ds_read_b64_tr_b16 v[32:33], v13 offset:19456
  ds_read_b64_tr_b16 v[34:35], v13 offset:19712
  v_mul_f32 v1, v52, v52
  v_mul_f32 v2, v53, v53
  s_waitcnt lgkmcnt(6)
  v_mfma_f32_32x32x16_bf16 v[112:127], v[152:155], v[28:31], v[112:127]
  v_mul_f32 v3, v54, v54
  ds_read_b64_tr_b16 v[36:37], v14 offset:19456
  ds_read_b64_tr_b16 v[38:39], v14 offset:19712
  v_mul_f32 v12, v55, v55
  v_fma_f32 v1, v1, v16, v15
  s_waitcnt lgkmcnt(4)
  v_mfma_f32_16x16x32_bf16 v[128:131], v[40:43], v[136:139], 0
  v_mfma_f32_16x16x32_bf16 v[132:135], v[40:43], v[140:143], 0
  v_fma_f32 v2, v2, v16, v15
  v_fma_f32 v3, v3, v16, v15
  s_waitcnt lgkmcnt(2)
  v_mfma_f32_32x32x16_bf16 v[96:111], v[32:35], v[156:159], v[96:111]
  v_fma_f32 v12, v12, v16, v15
  ds_read_b64_tr_b16 v[24:25], v13 offset:24576
  ds_read_b64_tr_b16 v[26:27], v13 offset:24832
  v_mul_f32 v1, v1, v52
  v_mul_f32 v2, v2, v53
  s_waitcnt lgkmcnt(2)
  v_mfma_f32_32x32x16_bf16 v[112:127], v[156:159], v[36:39], v[112:127]
  v_mul_f32 v3, v3, v54
  ds_read_b64_tr_b16 v[28:29], v14 offset:24576
  ds_read_b64_tr_b16 v[30:31], v14 offset:24832
  v_mul_f32 v12, v12, v55
  v_exp_f32 v1, v1
  s_waitcnt lgkmcnt(2)
  v_mfma_f32_32x32x16_bf16 v[96:111], v[24:27], v[160:163], v[96:111]
  v_exp_f32 v2, v2
  ds_read_b64_tr_b16 v[32:33], v13 offset:25600
  ds_read_b64_tr_b16 v[34:35], v13 offset:25856
  v_exp_f32 v3, v3
  v_exp_f32 v12, v12
  s_waitcnt lgkmcnt(2)
  v_mfma_f32_32x32x16_bf16 v[112:127], v[160:163], v[28:31], v[112:127]
  v_mul_f32 v52, v52, v60
  v_mul_f32 v53, v53, v61
  ds_read_b64_tr_b16 v[36:37], v14 offset:25600
  ds_read_b64_tr_b16 v[38:39], v14 offset:25856
  v_mul_f32 v54, v54, v62
  v_add_u32 v19, s57, v13
  ds_read_b64_tr_b16 v[136:137], v19 offset:24576
  ds_read_b64_tr_b16 v[138:139], v19 offset:24832
  v_add_u32 v20, s57, v14
  ds_read_b64_tr_b16 v[140:141], v20 offset:24576
  ds_read_b64_tr_b16 v[142:143], v20 offset:24832
  v_mul_f32 v55, v55, v63
  v_fma_f32 v1, v1, v17, v17
  s_waitcnt lgkmcnt(6)
  v_mfma_f32_32x32x16_bf16 v[96:111], v[32:35], v[164:167], v[96:111]
  v_fma_f32 v2, v2, v17, v17
  ds_read_b64_tr_b16 v[24:25], v13 offset:26624
  ds_read_b64_tr_b16 v[26:27], v13 offset:26880
  v_fma_f32 v3, v3, v17, v17
  v_fma_f32 v12, v12, v17, v17
  s_waitcnt lgkmcnt(6)
  v_mfma_f32_32x32x16_bf16 v[112:127], v[164:167], v[36:39], v[112:127]
  v_rcp_f32 v1, v1
  ds_read_b64_tr_b16 v[28:29], v14 offset:26624
  ds_read_b64_tr_b16 v[30:31], v14 offset:26880
  v_rcp_f32 v2, v2
  v_rcp_f32 v3, v3
  s_waitcnt lgkmcnt(4)
  v_mfma_f32_16x16x32_bf16 v[128:131], v[40:43], v[136:139], v[128:131]
  v_mfma_f32_16x16x32_bf16 v[132:135], v[40:43], v[140:143], v[132:135]
  v_rcp_f32 v12, v12
  s_waitcnt lgkmcnt(2)
  v_mfma_f32_32x32x16_bf16 v[96:111], v[24:27], v[168:171], v[96:111]
  v_mul_f32 v52, v52, v1
  v_mul_f32 v53, v53, v2
  ds_read_b64_tr_b16 v[32:33], v13 offset:27648
  ds_read_b64_tr_b16 v[34:35], v13 offset:27904
  v_mul_f32 v54, v54, v3
  v_mul_f32 v55, v55, v12
  s_waitcnt lgkmcnt(2)
  v_mfma_f32_32x32x16_bf16 v[112:127], v[168:171], v[28:31], v[112:127]
  v_cvt_pk_bf16_f32 v58, v52, v53
  ds_read_b64_tr_b16 v[36:37], v14 offset:27648
  ds_read_b64_tr_b16 v[38:39], v14 offset:27904
  v_cvt_pk_bf16_f32 v59, v54, v55
  s_add_u32 s54, s48, 0
  s_waitcnt lgkmcnt(2)
  v_mfma_f32_32x32x16_bf16 v[96:111], v[32:35], v[172:175], v[96:111]
  buffer_store_dwordx4 v[56:59], v22, s[16:19], s54 offen sc1
  ds_read_b64_tr_b16 v[24:25], v13 offset:28672
  ds_read_b64_tr_b16 v[26:27], v13 offset:28928
  v_mul_f32 v1, v64, v64
  v_mul_f32 v2, v65, v65
  s_waitcnt lgkmcnt(2)
  v_mfma_f32_32x32x16_bf16 v[112:127], v[172:175], v[36:39], v[112:127]
  v_mul_f32 v3, v66, v66
  ds_read_b64_tr_b16 v[28:29], v14 offset:28672
  ds_read_b64_tr_b16 v[30:31], v14 offset:28928
  v_mul_f32 v12, v67, v67
  v_fma_f32 v1, v1, v16, v15
  s_waitcnt lgkmcnt(2)
  v_mfma_f32_32x32x16_bf16 v[96:111], v[24:27], v[176:179], v[96:111]
  v_fma_f32 v2, v2, v16, v15
  v_fma_f32 v3, v3, v16, v15
  ds_read_b64_tr_b16 v[32:33], v13 offset:29696
  ds_read_b64_tr_b16 v[34:35], v13 offset:29952
  v_fma_f32 v12, v12, v16, v15
  s_waitcnt lgkmcnt(2)
  v_mfma_f32_32x32x16_bf16 v[112:127], v[176:179], v[28:31], v[112:127]
  v_mul_f32 v1, v1, v64
  v_mul_f32 v2, v2, v65
  ds_read_b64_tr_b16 v[36:37], v14 offset:29696
  ds_read_b64_tr_b16 v[38:39], v14 offset:29952
  v_mul_f32 v3, v3, v66
  s_waitcnt lgkmcnt(2)
  v_mfma_f32_32x32x16_bf16 v[96:111], v[32:35], v[180:183], v[96:111]
  v_mul_f32 v12, v12, v67
  v_exp_f32 v1, v1
  ds_read_b64_tr_b16 v[24:25], v13 offset:30720
  ds_read_b64_tr_b16 v[26:27], v13 offset:30976
  v_exp_f32 v2, v2
  s_waitcnt lgkmcnt(2)
  v_mfma_f32_32x32x16_bf16 v[112:127], v[180:183], v[36:39], v[112:127]
  v_exp_f32 v3, v3
  v_exp_f32 v12, v12
  ds_read_b64_tr_b16 v[28:29], v14 offset:30720
  ds_read_b64_tr_b16 v[30:31], v14 offset:30976
  v_mul_f32 v64, v64, v72
  s_waitcnt lgkmcnt(2)
  v_mfma_f32_32x32x16_bf16 v[96:111], v[24:27], v[184:187], v[96:111]
  v_mul_f32 v65, v65, v73
  v_mul_f32 v66, v66, v74
  ds_read_b64_tr_b16 v[32:33], v13 offset:31744
  ds_read_b64_tr_b16 v[34:35], v13 offset:32000
  v_mul_f32 v67, v67, v75
  v_fma_f32 v1, v1, v17, v17
  s_waitcnt lgkmcnt(2)
  v_mfma_f32_32x32x16_bf16 v[112:127], v[184:187], v[28:31], v[112:127]
  v_fma_f32 v2, v2, v17, v17
  ds_read_b64_tr_b16 v[36:37], v14 offset:31744
  ds_read_b64_tr_b16 v[38:39], v14 offset:32000
  v_fma_f32 v3, v3, v17, v17
  v_fma_f32 v12, v12, v17, v17
  s_waitcnt vmcnt(3)
  s_barrier
  v_rcp_f32 v1, v1
  s_waitcnt lgkmcnt(2)
  v_mfma_f32_32x32x16_bf16 v[96:111], v[32:35], v[188:191], v[96:111]
  v_rcp_f32 v2, v2
  v_rcp_f32 v3, v3
  ds_read_b64_tr_b16 v[24:25], v13 offset:0
  ds_read_b64_tr_b16 v[26:27], v13 offset:256
  v_rcp_f32 v12, v12
  s_waitcnt lgkmcnt(2)
  v_mfma_f32_32x32x16_bf16 v[112:127], v[188:191], v[36:39], v[112:127]
  v_mul_f32 v64, v64, v1
  v_mul_f32 v65, v65, v2
  ds_read_b64_tr_b16 v[28:29], v14 offset:0
  ds_read_b64_tr_b16 v[30:31], v14 offset:256
  v_mul_f32 v66, v66, v3
  v_mul_f32 v67, v67, v12
  s_waitcnt lgkmcnt(2)
  v_mfma_f32_32x32x16_bf16 v[96:111], v[24:27], v[192:195], v[96:111]
  v_cvt_pk_bf16_f32 v72, v64, v65
  ds_read_b64_tr_b16 v[32:33], v13 offset:1024
  ds_read_b64_tr_b16 v[34:35], v13 offset:1280
  v_cvt_pk_bf16_f32 v73, v66, v67
  v_mul_f32 v1, v68, v68
  s_waitcnt lgkmcnt(2)
  v_mfma_f32_32x32x16_bf16 v[112:127], v[192:195], v[28:31], v[112:127]
  v_mul_f32 v2, v69, v69
  ds_read_b64_tr_b16 v[36:37], v14 offset:1024
  ds_read_b64_tr_b16 v[38:39], v14 offset:1280
  v_mul_f32 v3, v70, v70
  v_mul_f32 v12, v71, v71
  v_add_u32 v19, s57, v13
  ds_read_b64_tr_b16 v[136:137], v19 offset:0
  ds_read_b64_tr_b16 v[138:139], v19 offset:256
  v_add_u32 v20, s57, v14
  ds_read_b64_tr_b16 v[140:141], v20 offset:0
  ds_read_b64_tr_b16 v[142:143], v20 offset:256
  v_fma_f32 v1, v1, v16, v15
  s_waitcnt lgkmcnt(6)
  v_mfma_f32_32x32x16_bf16 v[96:111], v[32:35], v[196:199], v[96:111]
  v_fma_f32 v2, v2, v16, v15
  v_fma_f32 v3, v3, v16, v15
  ds_read_b64_tr_b16 v[24:25], v13 offset:2048
  ds_read_b64_tr_b16 v[26:27], v13 offset:2304
  v_fma_f32 v12, v12, v16, v15
  v_mul_f32 v1, v1, v68
  s_waitcnt lgkmcnt(6)
  v_mfma_f32_32x32x16_bf16 v[112:127], v[196:199], v[36:39], v[112:127]
  v_mul_f32 v2, v2, v69
  ds_read_b64_tr_b16 v[28:29], v14 offset:2048
  ds_read_b64_tr_b16 v[30:31], v14 offset:2304
  v_mul_f32 v3, v3, v70
  v_mul_f32 v12, v12, v71
  s_waitcnt lgkmcnt(4)
  v_mfma_f32_16x16x32_bf16 v[128:131], v[40:43], v[136:139], v[128:131]
  v_mfma_f32_16x16x32_bf16 v[132:135], v[40:43], v[140:143], v[132:135]
  v_exp_f32 v1, v1
  s_waitcnt lgkmcnt(2)
  v_mfma_f32_32x32x16_bf16 v[96:111], v[24:27], v[200:203], v[96:111]
  v_exp_f32 v2, v2
  v_exp_f32 v3, v3
  ds_read_b64_tr_b16 v[32:33], v13 offset:3072
  ds_read_b64_tr_b16 v[34:35], v13 offset:3328
  v_exp_f32 v12, v12
  s_waitcnt lgkmcnt(2)
  v_mfma_f32_32x32x16_bf16 v[112:127], v[200:203], v[28:31], v[112:127]
  v_mul_f32 v68, v68, v76
  v_mul_f32 v69, v69, v77
  ds_read_b64_tr_b16 v[36:37], v14 offset:3072
  ds_read_b64_tr_b16 v[38:39], v14 offset:3328
  v_mul_f32 v70, v70, v78
  v_add_u32 v19, s57, v21
  ds_read_b64_tr_b16 v[136:137], v19 offset:0
  ds_read_b64_tr_b16 v[138:139], v19 offset:256
  v_add_u32 v20, s57, v23
  ds_read_b64_tr_b16 v[140:141], v20 offset:0
  ds_read_b64_tr_b16 v[142:143], v20 offset:256
  v_mul_f32 v71, v71, v79
  v_fma_f32 v1, v1, v17, v17
  s_waitcnt lgkmcnt(6)
  v_mfma_f32_32x32x16_bf16 v[96:111], v[32:35], v[204:207], v[96:111]
  v_fma_f32 v2, v2, v17, v17
  v_fma_f32 v3, v3, v17, v17
  ds_read_b64_tr_b16 v[24:25], v13 offset:4096
  ds_read_b64_tr_b16 v[26:27], v13 offset:4352
  v_fma_f32 v12, v12, v17, v17
  s_waitcnt lgkmcnt(6)
  v_mfma_f32_32x32x16_bf16 v[112:127], v[204:207], v[36:39], v[112:127]
  v_rcp_f32 v1, v1
  v_rcp_f32 v2, v2
  ds_read_b64_tr_b16 v[28:29], v14 offset:4096
  ds_read_b64_tr_b16 v[30:31], v14 offset:4352
  v_rcp_f32 v3, v3
  s_waitcnt lgkmcnt(4)
  v_mfma_f32_16x16x32_bf16 v[128:131], v[40:43], v[136:139], v[128:131]
  v_mfma_f32_16x16x32_bf16 v[132:135], v[40:43], v[140:143], v[132:135]
  v_rcp_f32 v12, v12
  v_mul_f32 v68, v68, v1
  s_waitcnt lgkmcnt(2)
  v_mfma_f32_32x32x16_bf16 v[96:111], v[24:27], v[208:211], v[96:111]
  v_mul_f32 v69, v69, v2
  ds_read_b64_tr_b16 v[32:33], v13 offset:5120
  ds_read_b64_tr_b16 v[34:35], v13 offset:5376
  v_mul_f32 v70, v70, v3
  v_mul_f32 v71, v71, v12
  s_waitcnt lgkmcnt(2)
  v_mfma_f32_32x32x16_bf16 v[112:127], v[208:211], v[28:31], v[112:127]
  v_cvt_pk_bf16_f32 v74, v68, v69
  v_cvt_pk_bf16_f32 v75, v70, v71
  ds_read_b64_tr_b16 v[36:37], v14 offset:5120
  ds_read_b64_tr_b16 v[38:39], v14 offset:5376
  s_add_u32 s54, s48, 1024
  s_lshr_b32 s59, s20, 2
  s_lshl_b32 s59, s59, 9
  s_and_b32 s56, s20, 3
  s_lshl_b32 s56, s56, 2
  s_add_u32 s59, s59, s56
  v_add_u32 v19, s59, v22
  s_mov_b64 exec, 0xffff
  v_cvt_pk_bf16_f32 v20, v128, v128
  v_lshlrev_b32 v20, 16, v20
  v_sub_f32 v144, v128, v20
  v_cvt_pk_bf16_f32 v128, v128, v144
  ds_write_b32 v19, v128 offset:3072
  v_cvt_pk_bf16_f32 v20, v129, v129
  v_lshlrev_b32 v20, 16, v20
  v_sub_f32 v144, v129, v20
  v_cvt_pk_bf16_f32 v129, v129, v144
  ds_write_b32 v19, v129 offset:3328
  v_cvt_pk_bf16_f32 v20, v132, v132
  v_lshlrev_b32 v20, 16, v20
  v_sub_f32 v144, v132, v20
  v_cvt_pk_bf16_f32 v132, v132, v144
  ds_write_b32 v19, v132 offset:4096
  v_cvt_pk_bf16_f32 v20, v133, v133
  v_lshlrev_b32 v20, 16, v20
  v_sub_f32 v144, v133, v20
  v_cvt_pk_bf16_f32 v133, v133, v144
  ds_write_b32 v19, v133 offset:4352
  s_mov_b64 exec, -1
  buffer_store_dwordx4 v[72:75], v22, s[16:19], s54 offen sc1
  v_mul_f32 v1, v80, v80
  s_waitcnt lgkmcnt(6)
  v_mfma_f32_32x32x16_bf16 v[96:111], v[32:35], v[212:215], v[96:111]
  v_mul_f32 v2, v81, v81
  ds_read_b64_tr_b16 v[24:25], v13 offset:6144
  ds_read_b64_tr_b16 v[26:27], v13 offset:6400
  v_mul_f32 v3, v82, v82
  v_mul_f32 v12, v83, v83
  s_waitcnt lgkmcnt(6)
  v_mfma_f32_32x32x16_bf16 v[112:127], v[212:215], v[36:39], v[112:127]
  v_fma_f32 v1, v1, v16, v15
  ds_read_b64_tr_b16 v[28:29], v14 offset:6144
  ds_read_b64_tr_b16 v[30:31], v14 offset:6400
  v_fma_f32 v2, v2, v16, v15
  v_fma_f32 v3, v3, v16, v15
  s_waitcnt lgkmcnt(2)
  v_mfma_f32_32x32x16_bf16 v[96:111], v[24:27], v[216:219], v[96:111]
  v_fma_f32 v12, v12, v16, v15
  ds_read_b64_tr_b16 v[32:33], v13 offset:7168
  ds_read_b64_tr_b16 v[34:35], v13 offset:7424
  v_mul_f32 v1, v1, v80
  v_mul_f32 v2, v2, v81
  s_waitcnt lgkmcnt(2)
  v_mfma_f32_32x32x16_bf16 v[112:127], v[216:219], v[28:31], v[112:127]
  v_mul_f32 v3, v3, v82
  v_mul_f32 v12, v12, v83
  ds_read_b64_tr_b16 v[36:37], v14 offset:7168
  ds_read_b64_tr_b16 v[38:39], v14 offset:7424
  v_exp_f32 v1, v1
  s_waitcnt lgkmcnt(2)
  v_mfma_f32_32x32x16_bf16 v[96:111], v[32:35], v[220:223], v[96:111]
  v_exp_f32 v2, v2
  v_exp_f32 v3, v3
  ds_read_b64_tr_b16 v[24:25], v21 offset:0
  ds_read_b64_tr_b16 v[26:27], v21 offset:256
  v_exp_f32 v12, v12
  s_waitcnt lgkmcnt(2)
  v_mfma_f32_32x32x16_bf16 v[112:127], v[220:223], v[36:39], v[112:127]
  v_mul_f32 v80, v80, v88
  v_mul_f32 v81, v81, v89
  ds_read_b64_tr_b16 v[28:29], v23 offset:0
  ds_read_b64_tr_b16 v[30:31], v23 offset:256
  v_mul_f32 v82, v82, v90
  s_barrier
  v_mul_f32 v83, v83, v91
  v_fma_f32 v1, v1, v17, v17
  s_waitcnt lgkmcnt(2)
  v_mfma_f32_32x32x16_bf16 v[96:111], v[24:27], v[224:227], v[96:111]
  v_fma_f32 v2, v2, v17, v17
  v_fma_f32 v3, v3, v17, v17
  ds_read_b64_tr_b16 v[32:33], v21 offset:1024
  ds_read_b64_tr_b16 v[34:35], v21 offset:1280
  v_fma_f32 v12, v12, v17, v17
  s_waitcnt lgkmcnt(2)
  v_mfma_f32_32x32x16_bf16 v[112:127], v[224:227], v[28:31], v[112:127]
  v_rcp_f32 v1, v1
  v_rcp_f32 v2, v2
  ds_read_b64_tr_b16 v[36:37], v23 offset:1024
  ds_read_b64_tr_b16 v[38:39], v23 offset:1280
  v_rcp_f32 v3, v3
  s_waitcnt lgkmcnt(2)
  v_mfma_f32_32x32x16_bf16 v[96:111], v[32:35], v[228:231], v[96:111]
  v_rcp_f32 v12, v12
  v_mul_f32 v80, v80, v1
  ds_read_b64_tr_b16 v[24:25], v21 offset:2048
  ds_read_b64_tr_b16 v[26:27], v21 offset:2304
  v_mul_f32 v81, v81, v2
  s_waitcnt lgkmcnt(2)
  v_mfma_f32_32x32x16_bf16 v[112:127], v[228:231], v[36:39], v[112:127]
  v_mul_f32 v82, v82, v3
  v_mul_f32 v83, v83, v12
  ds_read_b64_tr_b16 v[28:29], v23 offset:2048
  ds_read_b64_tr_b16 v[30:31], v23 offset:2304
  v_cvt_pk_bf16_f32 v88, v80, v81
  v_cvt_pk_bf16_f32 v89, v82, v83
  ds_read_b128 v[144:147], v22 offset:3072
  ds_read_b128 v[148:151], v22 offset:4096
  v_lshrrev_b32 v19, 5, v0
  v_lshlrev_b32 v20, 4, v19
  s_lshl_b32 s59, s20, 7
  v_add_u32 v20, s59, v20
  ds_read_b128 v[176:179], v20 offset:5120
  ds_read_b128 v[180:183], v20 offset:5152
  ds_read_b128 v[184:187], v20 offset:5184
  ds_read_b128 v[188:191], v20 offset:5216
  v_bfe_u32 v152, v0, 4, 1
  v_lshlrev_b32 v152, 16, v152
  v_lshl_add_u32 v152, v19, 8, v152
  v_and_b32 v19, 15, v0
  v_lshl_add_u32 v152, v19, 4, v152
  v_mul_f32 v1, v84, v84
  s_waitcnt lgkmcnt(8)
  v_mfma_f32_32x32x16_bf16 v[96:111], v[24:27], v[232:235], v[96:111]
  v_mul_f32 v2, v85, v85
  v_mul_f32 v3, v86, v86
  ds_read_b64_tr_b16 v[32:33], v21 offset:3072
  ds_read_b64_tr_b16 v[34:35], v21 offset:3328
  v_mul_f32 v12, v87, v87
  s_waitcnt lgkmcnt(8)
  v_mfma_f32_32x32x16_bf16 v[112:127], v[232:235], v[28:31], v[112:127]
  v_fma_f32 v1, v1, v16, v15
  v_fma_f32 v2, v2, v16, v15
  ds_read_b64_tr_b16 v[36:37], v23 offset:3072
  ds_read_b64_tr_b16 v[38:39], v23 offset:3328
  v_fma_f32 v3, v3, v16, v15
  s_waitcnt lgkmcnt(2)
  v_mfma_f32_32x32x16_bf16 v[96:111], v[32:35], v[236:239], v[96:111]
  v_fma_f32 v12, v12, v16, v15
  v_mul_f32 v1, v1, v84
  ds_read_b64_tr_b16 v[24:25], v21 offset:4096
  ds_read_b64_tr_b16 v[26:27], v21 offset:4352
  v_mul_f32 v2, v2, v85
  s_waitcnt lgkmcnt(2)
  v_mfma_f32_32x32x16_bf16 v[112:127], v[236:239], v[36:39], v[112:127]
  v_mul_f32 v3, v3, v86
  v_mul_f32 v12, v12, v87
  ds_read_b64_tr_b16 v[28:29], v23 offset:4096
  ds_read_b64_tr_b16 v[30:31], v23 offset:4352
  v_exp_f32 v1, v1
  v_exp_f32 v2, v2
  s_waitcnt lgkmcnt(2)
  v_mfma_f32_32x32x16_bf16 v[96:111], v[24:27], v[240:243], v[96:111]
  v_exp_f32 v3, v3
  ds_read_b64_tr_b16 v[32:33], v21 offset:5120
  ds_read_b64_tr_b16 v[34:35], v21 offset:5376
  v_exp_f32 v12, v12
  v_mul_f32 v84, v84, v92
  s_waitcnt lgkmcnt(2)
  v_mfma_f32_32x32x16_bf16 v[112:127], v[240:243], v[28:31], v[112:127]
  v_mul_f32 v85, v85, v93
  ds_read_b64_tr_b16 v[36:37], v23 offset:5120
  ds_read_b64_tr_b16 v[38:39], v23 offset:5376
  v_mul_f32 v86, v86, v94
  v_mul_f32 v87, v87, v95
  s_waitcnt lgkmcnt(2)
  v_mfma_f32_32x32x16_bf16 v[96:111], v[32:35], v[244:247], v[96:111]
  v_fma_f32 v1, v1, v17, v17
  ds_read_b64_tr_b16 v[24:25], v21 offset:6144
  ds_read_b64_tr_b16 v[26:27], v21 offset:6400
  v_fma_f32 v2, v2, v17, v17
  v_fma_f32 v3, v3, v17, v17
  s_waitcnt lgkmcnt(2)
  v_mfma_f32_32x32x16_bf16 v[112:127], v[244:247], v[36:39], v[112:127]
  v_fma_f32 v12, v12, v17, v17
  v_rcp_f32 v1, v1
  ds_read_b64_tr_b16 v[28:29], v23 offset:6144
  ds_read_b64_tr_b16 v[30:31], v23 offset:6400
  v_rcp_f32 v2, v2
  s_waitcnt lgkmcnt(2)
  v_mfma_f32_32x32x16_bf16 v[96:111], v[24:27], v[248:251], v[96:111]
  v_rcp_f32 v3, v3
  v_rcp_f32 v12, v12
  ds_read_b64_tr_b16 v[32:33], v21 offset:7168
  ds_read_b64_tr_b16 v[34:35], v21 offset:7424
  v_mul_f32 v84, v84, v1
  s_waitcnt lgkmcnt(2)
  v_mfma_f32_32x32x16_bf16 v[112:127], v[248:251], v[28:31], v[112:127]
  v_mul_f32 v85, v85, v2
  v_mul_f32 v86, v86, v3
  ds_read_b64_tr_b16 v[36:37], v23 offset:7168
  ds_read_b64_tr_b16 v[38:39], v23 offset:7424
  v_mul_f32 v87, v87, v12
  s_waitcnt lgkmcnt(2)
  v_mfma_f32_32x32x16_bf16 v[96:111], v[32:35], v[252:255], v[96:111]
  v_cvt_pk_bf16_f32 v90, v84, v85
  v_cvt_pk_bf16_f32 v91, v86, v87
  s_waitcnt lgkmcnt(0)
  v_mfma_f32_32x32x16_bf16 v[112:127], v[252:255], v[36:39], v[112:127]
  s_add_u32 s54, s48, 2048
  buffer_store_dwordx4 v[88:91], v22, s[16:19], s54 offen sc1
  v_mfma_f32_32x32x16_bf16 v[96:111], v[144:147], v[4:7], v[96:111]
  v_mfma_f32_32x32x16_bf16 v[112:127], v[4:7], v[148:151], v[112:127]
  v_mul_f32 v1, s51, v18
  s_nop 9
  v_mul_f32 v96, v96, v1
  v_mul_f32 v97, v97, v1
  v_mul_f32 v98, v98, v1
  v_mul_f32 v99, v99, v1
  v_mul_f32 v100, v100, v1
  v_mul_f32 v101, v101, v1
  v_mul_f32 v102, v102, v1
  v_mul_f32 v103, v103, v1
  v_mul_f32 v104, v104, v1
  v_mul_f32 v105, v105, v1
  v_mul_f32 v106, v106, v1
  v_mul_f32 v107, v107, v1
  v_mul_f32 v108, v108, v1
  v_mul_f32 v109, v109, v1
  v_mul_f32 v110, v110, v1
  v_mul_f32 v111, v111, v1
  v_cvt_pk_bf16_f32 v160, v96, v97
  v_cvt_pk_bf16_f32 v161, v98, v99
  v_cvt_pk_bf16_f32 v162, v100, v101
  v_cvt_pk_bf16_f32 v163, v102, v103
  v_cvt_pk_bf16_f32 v164, v104, v105
  v_cvt_pk_bf16_f32 v165, v106, v107
  v_cvt_pk_bf16_f32 v166, v108, v109
  v_cvt_pk_bf16_f32 v167, v110, v111
  s_add_u32 s54, s49, 65536
  buffer_store_dwordx4 v[160:163], v22, s[16:19], s49 offen sc1
  buffer_store_dwordx4 v[164:167], v22, s[16:19], s54 offen sc1
  v_mul_f32 v112, v112, v176
  v_mul_f32 v113, v113, v177
  v_mul_f32 v114, v114, v178
  v_mul_f32 v115, v115, v179
  v_mul_f32 v116, v116, v180
  v_mul_f32 v117, v117, v181
  v_mul_f32 v118, v118, v182
  v_mul_f32 v119, v119, v183
  v_mul_f32 v120, v120, v184
  v_mul_f32 v121, v121, v185
  v_mul_f32 v122, v122, v186
  v_mul_f32 v123, v123, v187
  v_mul_f32 v124, v124, v188
  v_mul_f32 v125, v125, v189
  v_mul_f32 v126, v126, v190
  v_mul_f32 v127, v127, v191
  v_cvt_pk_bf16_f32 v192, v112, v113
  v_cvt_pk_bf16_f32 v193, v114, v115
  v_cvt_pk_bf16_f32 v194, v116, v117
  v_cvt_pk_bf16_f32 v195, v118, v119
  v_cvt_pk_bf16_f32 v196, v120, v121
  v_cvt_pk_bf16_f32 v197, v122, v123
  v_cvt_pk_bf16_f32 v198, v124, v125
  v_cvt_pk_bf16_f32 v199, v126, v127
  buffer_store_dwordx4 v[192:195], v152, s[16:19], s50 offen sc1
  buffer_store_dwordx4 v[196:199], v152, s[16:19], s50 offen offset:512 sc1
  s_endpgm
K1_VARB:
  ds_read_b64_tr_b16 v[24:25], v13 offset:12288
  ds_read_b64_tr_b16 v[26:27], v13 offset:12544
  ds_read_b64_tr_b16 v[28:29], v14 offset:12288
  ds_read_b64_tr_b16 v[30:31], v14 offset:12416
  s_waitcnt lgkmcnt(2)
  v_mfma_f32_32x32x16_bf16 v[96:111], v[24:27], v[128:131], 0
  ds_read_b128 v[8:11], v22 offset:0
  ds_read_b64_tr_b16 v[32:33], v13 offset:13312
  ds_read_b64_tr_b16 v[34:35], v13 offset:13568
  s_waitcnt lgkmcnt(2)
  v_mfma_f32_32x32x16_bf16 v[48:63], v[8:11], v[4:7], v[48:63]
  v_mfma_f32_32x32x16_bf16 v[112:127], v[28:31], v[128:131], 0
  ds_read_b128 v[8:11], v22 offset:1024
  ds_read_b64_tr_b16 v[36:37], v14 offset:12800
  ds_read_b64_tr_b16 v[38:39], v14 offset:12928
  s_waitcnt lgkmcnt(2)
  v_mfma_f32_32x32x16_bf16 v[64:79], v[8:11], v[4:7], v[64:79]
  v_mfma_f32_32x32x16_bf16 v[96:111], v[32:35], v[132:135], v[96:111]
  ds_read_b128 v[8:11], v22 offset:2048
  ds_read_b64_tr_b16 v[24:25], v13 offset:14336
  ds_read_b64_tr_b16 v[26:27], v13 offset:14592
  s_waitcnt lgkmcnt(2)
  v_mfma_f32_32x32x16_bf16 v[80:95], v[8:11], v[4:7], v[80:95]
  v_mfma_f32_32x32x16_bf16 v[112:127], v[36:39], v[132:135], v[112:127]
  v_mul_f32 v1, v48, v48
  ds_read_b64_tr_b16 v[28:29], v14 offset:13312
  ds_read_b64_tr_b16 v[30:31], v14 offset:13440
  v_mul_f32 v2, v49, v49
  v_mul_f32 v3, v50, v50
  s_waitcnt lgkmcnt(2)
  v_mfma_f32_32x32x16_bf16 v[96:111], v[24:27], v[136:139], v[96:111]
  v_mul_f32 v12, v51, v51
  v_fma_f32 v1, v1, v16, v15
  ds_read_b64_tr_b16 v[32:33], v13 offset:15360
  ds_read_b64_tr_b16 v[34:35], v13 offset:15616
  v_fma_f32 v2, v2, v16, v15
  s_waitcnt lgkmcnt(2)
  v_mfma_f32_32x32x16_bf16 v[112:127], v[28:31], v[136:139], v[112:127]
  v_fma_f32 v3, v3, v16, v15
  v_fma_f32 v12, v12, v16, v15
  ds_read_b64_tr_b16 v[36:37], v14 offset:13824
  ds_read_b64_tr_b16 v[38:39], v14 offset:13952
  v_mul_f32 v1, v1, v48
  s_mov_b32 s62, 1835008
  s_mov_b32 s63, 0x20000
  s_mov_b32 s98, 0x80000
  s_mov_b32 s99, 0x20000
  s_lshl_b32 s59, s2, 3
  s_add_u32 s59, s59, s20
  s_lshl_b32 s59, s59, 10
  buffer_load_dwordx4 v[44:47], v22, s[60:63], s59 offen
  buffer_load_dwordx4 v[44:47], v22, s[96:99], s59 offen
  v_mul_f32 v2, v2, v49
  v_mul_f32 v3, v3, v50
  s_waitcnt lgkmcnt(2)
  v_mfma_f32_32x32x16_bf16 v[96:111], v[32:35], v[140:143], v[96:111]
  v_mul_f32 v12, v12, v51
  ds_read_b64_tr_b16 v[24:25], v13 offset:16384
  ds_read_b64_tr_b16 v[26:27], v13 offset:16640
  v_exp_f32 v1, v1
  v_exp_f32 v2, v2
  s_waitcnt lgkmcnt(2)
  v_mfma_f32_32x32x16_bf16 v[112:127], v[36:39], v[140:143], v[112:127]
  v_exp_f32 v3, v3
  v_exp_f32 v12, v12
  ds_read_b64_tr_b16 v[28:29], v14 offset:14336
  ds_read_b64_tr_b16 v[30:31], v14 offset:14464
  v_mul_f32 v48, v48, v56
  s_cmp_ge_u32 s20, 4
  s_cbranch_scc1 K1_TCB1
  s_getpc_b64 s[52:53]
K1_TCB1P:
  s_sub_u32 s52, s52, K1_TCB1P-k1_kernel
  s_subb_u32 s53, s53, 0
  s_lshl_b32 s56, s20, 13
  s_add_u32 s56, s56, 16384
  v_lshl_add_u32 v19, v0, 7, s56
  v_min_u32 v19, CODE_END-k1_kernel-4, v19
  global_load_dword v47, v19, s[52:53]
K1_TCB1:
  v_mul_f32 v49, v49, v57
  v_mul_f32 v50, v50, v58
  s_waitcnt lgkmcnt(2)
  v_mfma_f32_32x32x16_bf16 v[96:111], v[24:27], v[144:147], v[96:111]
  v_mul_f32 v51, v51, v59
  ds_read_b64_tr_b16 v[32:33], v13 offset:17408
  ds_read_b64_tr_b16 v[34:35], v13 offset:17664
  v_fma_f32 v1, v1, v17, v17
  v_fma_f32 v2, v2, v17, v17
  s_waitcnt lgkmcnt(2)
  v_mfma_f32_32x32x16_bf16 v[112:127], v[28:31], v[144:147], v[112:127]
  v_fma_f32 v3, v3, v17, v17
  ds_read_b64_tr_b16 v[36:37], v14 offset:14848
  ds_read_b64_tr_b16 v[38:39], v14 offset:14976
  v_fma_f32 v12, v12, v17, v17
  v_rcp_f32 v1, v1
  s_waitcnt lgkmcnt(2)
  v_mfma_f32_32x32x16_bf16 v[96:111], v[32:35], v[148:151], v[96:111]
  v_rcp_f32 v2, v2
  ds_read_b64_tr_b16 v[24:25], v13 offset:18432
  ds_read_b64_tr_b16 v[26:27], v13 offset:18688
  v_rcp_f32 v3, v3
  v_rcp_f32 v12, v12
  s_waitcnt lgkmcnt(2)
  v_mfma_f32_32x32x16_bf16 v[112:127], v[36:39], v[148:151], v[112:127]
  v_mul_f32 v48, v48, v1
  v_mul_f32 v49, v49, v2
  ds_read_b64_tr_b16 v[28:29], v14 offset:15360
  ds_read_b64_tr_b16 v[30:31], v14 offset:15488
  v_mul_f32 v50, v50, v3
  v_add_u32 v19, s57, v13
  ds_read_b64_tr_b16 v[136:137], v19 offset:12288
  ds_read_b64_tr_b16 v[138:139], v19 offset:12544
  v_add_u32 v20, s58, v14
  ds_read_b64_tr_b16 v[140:141], v20 offset:12288
  ds_read_b64_tr_b16 v[142:143], v20 offset:12416
  v_mul_f32 v51, v51, v12
  v_cvt_pk_bf16_f32 v56, v48, v49
  s_waitcnt lgkmcnt(6)
  v_mfma_f32_32x32x16_bf16 v[96:111], v[24:27], v[152:155], v[96:111]
  v_cvt_pk_bf16_f32 v57, v50, v51
  ds_read_b64_tr_b16 v[32:33], v13 offset:19456
  ds_read_b64_tr_b16 v[34:35], v13 offset:19712
  v_mul_f32 v1, v52, v52
  v_mul_f32 v2, v53, v53
  s_waitcnt lgkmcnt(6)
  v_mfma_f32_32x32x16_bf16 v[112:127], v[28:31], v[152:155], v[112:127]
  v_mul_f32 v3, v54, v54
  ds_read_b64_tr_b16 v[36:37], v14 offset:15872
  ds_read_b64_tr_b16 v[38:39], v14 offset:16000
  v_mul_f32 v12, v55, v55
  v_fma_f32 v1, v1, v16, v15
  s_waitcnt lgkmcnt(4)
  v_mfma_f32_16x16x32_bf16 v[128:131], v[40:43], v[136:139], 0
  v_mfma_f32_16x16x32_bf16 v[132:135], v[40:43], v[140:143], 0
  v_fma_f32 v2, v2, v16, v15
  v_fma_f32 v3, v3, v16, v15
  s_waitcnt lgkmcnt(2)
  v_mfma_f32_32x32x16_bf16 v[96:111], v[32:35], v[156:159], v[96:111]
  v_fma_f32 v12, v12, v16, v15
  ds_read_b64_tr_b16 v[24:25], v13 offset:24576
  ds_read_b64_tr_b16 v[26:27], v13 offset:24832
  v_mul_f32 v1, v1, v52
  v_mul_f32 v2, v2, v53
  s_waitcnt lgkmcnt(2)
  v_mfma_f32_32x32x16_bf16 v[112:127], v[36:39], v[156:159], v[112:127]
  v_mul_f32 v3, v3, v54
  ds_read_b64_tr_b16 v[28:29], v14 offset:24576
  ds_read_b64_tr_b16 v[30:31], v14 offset:24704
  v_mul_f32 v12, v12, v55
  v_exp_f32 v1, v1
  s_waitcnt lgkmcnt(2)
  v_mfma_f32_32x32x16_bf16 v[96:111], v[24:27], v[160:163], v[96:111]
  v_exp_f32 v2, v2
  ds_read_b64_tr_b16 v[32:33], v13 offset:25600
  ds_read_b64_tr_b16 v[34:35], v13 offset:25856
  v_exp_f32 v3, v3
  v_exp_f32 v12, v12
  s_waitcnt lgkmcnt(2)
  v_mfma_f32_32x32x16_bf16 v[112:127], v[28:31], v[160:163], v[112:127]
  v_mul_f32 v52, v52, v60
  v_mul_f32 v53, v53, v61
  ds_read_b64_tr_b16 v[36:37], v14 offset:25088
  ds_read_b64_tr_b16 v[38:39], v14 offset:25216
  v_mul_f32 v54, v54, v62
  v_add_u32 v19, s57, v13
  ds_read_b64_tr_b16 v[136:137], v19 offset:24576
  ds_read_b64_tr_b16 v[138:139], v19 offset:24832
  v_add_u32 v20, s58, v14
  ds_read_b64_tr_b16 v[140:141], v20 offset:24576
  ds_read_b64_tr_b16 v[142:143], v20 offset:24704
  v_mul_f32 v55, v55, v63
  v_fma_f32 v1, v1, v17, v17
  s_waitcnt lgkmcnt(6)
  v_mfma_f32_32x32x16_bf16 v[96:111], v[32:35], v[164:167], v[96:111]
  v_fma_f32 v2, v2, v17, v17
  ds_read_b64_tr_b16 v[24:25], v13 offset:26624
  ds_read_b64_tr_b16 v[26:27], v13 offset:26880
  v_fma_f32 v3, v3, v17, v17
  v_fma_f32 v12, v12, v17, v17
  s_waitcnt lgkmcnt(6)
  v_mfma_f32_32x32x16_bf16 v[112:127], v[36:39], v[164:167], v[112:127]
  v_rcp_f32 v1, v1
  ds_read_b64_tr_b16 v[28:29], v14 offset:25600
  ds_read_b64_tr_b16 v[30:31], v14 offset:25728
  v_rcp_f32 v2, v2
  v_rcp_f32 v3, v3
  s_waitcnt lgkmcnt(4)
  v_mfma_f32_16x16x32_bf16 v[128:131], v[40:43], v[136:139], v[128:131]
  v_mfma_f32_16x16x32_bf16 v[132:135], v[40:43], v[140:143], v[132:135]
  v_rcp_f32 v12, v12
  s_waitcnt lgkmcnt(2)
  v_mfma_f32_32x32x16_bf16 v[96:111], v[24:27], v[168:171], v[96:111]
  v_mul_f32 v52, v52, v1
  v_mul_f32 v53, v53, v2
  ds_read_b64_tr_b16 v[32:33], v13 offset:27648
  ds_read_b64_tr_b16 v[34:35], v13 offset:27904
  v_mul_f32 v54, v54, v3
  v_mul_f32 v55, v55, v12
  s_waitcnt lgkmcnt(2)
  v_mfma_f32_32x32x16_bf16 v[112:127], v[28:31], v[168:171], v[112:127]
  v_cvt_pk_bf16_f32 v58, v52, v53
  ds_read_b64_tr_b16 v[36:37], v14 offset:26112
  ds_read_b64_tr_b16 v[38:39], v14 offset:26240
  v_cvt_pk_bf16_f32 v59, v54, v55
  s_add_u32 s54, s48, 0
  s_waitcnt lgkmcnt(2)
  v_mfma_f32_32x32x16_bf16 v[96:111], v[32:35], v[172:175], v[96:111]
  buffer_store_dwordx4 v[56:59], v22, s[16:19], s54 offen sc1
  ds_read_b64_tr_b16 v[24:25], v13 offset:28672
  ds_read_b64_tr_b16 v[26:27], v13 offset:28928
  v_mul_f32 v1, v64, v64
  v_mul_f32 v2, v65, v65
  s_waitcnt lgkmcnt(2)
  v_mfma_f32_32x32x16_bf16 v[112:127], v[36:39], v[172:175], v[112:127]
  v_mul_f32 v3, v66, v66
  ds_read_b64_tr_b16 v[28:29], v14 offset:26624
  ds_read_b64_tr_b16 v[30:31], v14 offset:26752
  v_mul_f32 v12, v67, v67
  v_fma_f32 v1, v1, v16, v15
  s_waitcnt lgkmcnt(2)
  v_mfma_f32_32x32x16_bf16 v[96:111], v[24:27], v[176:179], v[96:111]
  v_fma_f32 v2, v2, v16, v15
  v_fma_f32 v3, v3, v16, v15
  ds_read_b64_tr_b16 v[32:33], v13 offset:29696
  ds_read_b64_tr_b16 v[34:35], v13 offset:29952
  v_fma_f32 v12, v12, v16, v15
  s_waitcnt lgkmcnt(2)
  v_mfma_f32_32x32x16_bf16 v[112:127], v[28:31], v[176:179], v[112:127]
  v_mul_f32 v1, v1, v64
  v_mul_f32 v2, v2, v65
  ds_read_b64_tr_b16 v[36:37], v14 offset:27136
  ds_read_b64_tr_b16 v[38:39], v14 offset:27264
  v_mul_f32 v3, v3, v66
  s_waitcnt lgkmcnt(2)
  v_mfma_f32_32x32x16_bf16 v[96:111], v[32:35], v[180:183], v[96:111]
  v_mul_f32 v12, v12, v67
  v_exp_f32 v1, v1
  ds_read_b64_tr_b16 v[24:25], v13 offset:30720
  ds_read_b64_tr_b16 v[26:27], v13 offset:30976
  v_exp_f32 v2, v2
  s_waitcnt lgkmcnt(2)
  v_mfma_f32_32x32x16_bf16 v[112:127], v[36:39], v[180:183], v[112:127]
  v_exp_f32 v3, v3
  v_exp_f32 v12, v12
  ds_read_b64_tr_b16 v[28:29], v14 offset:27648
  ds_read_b64_tr_b16 v[30:31], v14 offset:27776
  v_mul_f32 v64, v64, v72
  s_waitcnt lgkmcnt(2)
  v_mfma_f32_32x32x16_bf16 v[96:111], v[24:27], v[184:187], v[96:111]
  v_mul_f32 v65, v65, v73
  v_mul_f32 v66, v66, v74
  ds_read_b64_tr_b16 v[32:33], v13 offset:31744
  ds_read_b64_tr_b16 v[34:35], v13 offset:32000
  v_mul_f32 v67, v67, v75
  v_fma_f32 v1, v1, v17, v17
  s_waitcnt lgkmcnt(2)
  v_mfma_f32_32x32x16_bf16 v[112:127], v[28:31], v[184:187], v[112:127]
  v_fma_f32 v2, v2, v17, v17
  ds_read_b64_tr_b16 v[36:37], v14 offset:28160
  ds_read_b64_tr_b16 v[38:39], v14 offset:28288
  v_fma_f32 v3, v3, v17, v17
  v_fma_f32 v12, v12, v17, v17
  s_waitcnt vmcnt(3)
  s_barrier
  v_rcp_f32 v1, v1
  s_waitcnt lgkmcnt(2)
  v_mfma_f32_32x32x16_bf16 v[96:111], v[32:35], v[188:191], v[96:111]
  v_rcp_f32 v2, v2
  v_rcp_f32 v3, v3
  ds_read_b64_tr_b16 v[24:25], v13 offset:0
  ds_read_b64_tr_b16 v[26:27], v13 offset:256
  v_rcp_f32 v12, v12
  s_waitcnt lgkmcnt(2)
  v_mfma_f32_32x32x16_bf16 v[112:127], v[36:39], v[188:191], v[112:127]
  v_mul_f32 v64, v64, v1
  v_mul_f32 v65, v65, v2
  ds_read_b64_tr_b16 v[28:29], v14 offset:0
  ds_read_b64_tr_b16 v[30:31], v14 offset:128
  v_mul_f32 v66, v66, v3
  v_mul_f32 v67, v67, v12
  s_waitcnt lgkmcnt(2)
  v_mfma_f32_32x32x16_bf16 v[96:111], v[24:27], v[192:195], v[96:111]
  v_cvt_pk_bf16_f32 v72, v64, v65
  ds_read_b64_tr_b16 v[32:33], v13 offset:1024
  ds_read_b64_tr_b16 v[34:35], v13 offset:1280
  v_cvt_pk_bf16_f32 v73, v66, v67
  v_mul_f32 v1, v68, v68
  s_waitcnt lgkmcnt(2)
  v_mfma_f32_32x32x16_bf16 v[112:127], v[28:31], v[192:195], v[112:127]
  v_mul_f32 v2, v69, v69
  ds_read_b64_tr_b16 v[36:37], v14 offset:512
  ds_read_b64_tr_b16 v[38:39], v14 offset:640
  v_mul_f32 v3, v70, v70
  v_mul_f32 v12, v71, v71
  v_add_u32 v19, s57, v13
  ds_read_b64_tr_b16 v[136:137], v19 offset:0
  ds_read_b64_tr_b16 v[138:139], v19 offset:256
  v_add_u32 v20, s58, v14
  ds_read_b64_tr_b16 v[140:141], v20 offset:0
  ds_read_b64_tr_b16 v[142:143], v20 offset:128
  v_fma_f32 v1, v1, v16, v15
  s_waitcnt lgkmcnt(6)
  v_mfma_f32_32x32x16_bf16 v[96:111], v[32:35], v[196:199], v[96:111]
  v_fma_f32 v2, v2, v16, v15
  v_fma_f32 v3, v3, v16, v15
  ds_read_b64_tr_b16 v[24:25], v13 offset:2048
  ds_read_b64_tr_b16 v[26:27], v13 offset:2304
  v_fma_f32 v12, v12, v16, v15
  v_mul_f32 v1, v1, v68
  s_waitcnt lgkmcnt(6)
  v_mfma_f32_32x32x16_bf16 v[112:127], v[36:39], v[196:199], v[112:127]
  v_mul_f32 v2, v2, v69
  ds_read_b64_tr_b16 v[28:29], v14 offset:1024
  ds_read_b64_tr_b16 v[30:31], v14 offset:1152
  v_mul_f32 v3, v3, v70
  v_mul_f32 v12, v12, v71
  s_waitcnt lgkmcnt(4)
  v_mfma_f32_16x16x32_bf16 v[128:131], v[40:43], v[136:139], v[128:131]
  v_mfma_f32_16x16x32_bf16 v[132:135], v[40:43], v[140:143], v[132:135]
  v_exp_f32 v1, v1
  s_waitcnt lgkmcnt(2)
  v_mfma_f32_32x32x16_bf16 v[96:111], v[24:27], v[200:203], v[96:111]
  v_exp_f32 v2, v2
  v_exp_f32 v3, v3
  ds_read_b64_tr_b16 v[32:33], v13 offset:3072
  ds_read_b64_tr_b16 v[34:35], v13 offset:3328
  v_exp_f32 v12, v12
  s_waitcnt lgkmcnt(2)
  v_mfma_f32_32x32x16_bf16 v[112:127], v[28:31], v[200:203], v[112:127]
  v_mul_f32 v68, v68, v76
  v_mul_f32 v69, v69, v77
  ds_read_b64_tr_b16 v[36:37], v14 offset:1536
  ds_read_b64_tr_b16 v[38:39], v14 offset:1664
  v_mul_f32 v70, v70, v78
  v_add_u32 v19, s57, v21
  ds_read_b64_tr_b16 v[136:137], v19 offset:0
  ds_read_b64_tr_b16 v[138:139], v19 offset:256
  v_add_u32 v20, s58, v23
  ds_read_b64_tr_b16 v[140:141], v20 offset:0
  ds_read_b64_tr_b16 v[142:143], v20 offset:128
  v_mul_f32 v71, v71, v79
  v_fma_f32 v1, v1, v17, v17
  s_waitcnt lgkmcnt(6)
  v_mfma_f32_32x32x16_bf16 v[96:111], v[32:35], v[204:207], v[96:111]
  v_fma_f32 v2, v2, v17, v17
  v_fma_f32 v3, v3, v17, v17
  ds_read_b64_tr_b16 v[24:25], v13 offset:4096
  ds_read_b64_tr_b16 v[26:27], v13 offset:4352
  v_fma_f32 v12, v12, v17, v17
  s_waitcnt lgkmcnt(6)
  v_mfma_f32_32x32x16_bf16 v[112:127], v[36:39], v[204:207], v[112:127]
  v_rcp_f32 v1, v1
  v_rcp_f32 v2, v2
  ds_read_b64_tr_b16 v[28:29], v14 offset:2048
  ds_read_b64_tr_b16 v[30:31], v14 offset:2176
  v_rcp_f32 v3, v3
  s_waitcnt lgkmcnt(4)
  v_mfma_f32_16x16x32_bf16 v[128:131], v[40:43], v[136:139], v[128:131]
  v_mfma_f32_16x16x32_bf16 v[132:135], v[40:43], v[140:143], v[132:135]
  v_rcp_f32 v12, v12
  v_mul_f32 v68, v68, v1
  s_waitcnt lgkmcnt(2)
  v_mfma_f32_32x32x16_bf16 v[96:111], v[24:27], v[208:211], v[96:111]
  v_mul_f32 v69, v69, v2
  ds_read_b64_tr_b16 v[32:33], v13 offset:5120
  ds_read_b64_tr_b16 v[34:35], v13 offset:5376
  v_mul_f32 v70, v70, v3
  v_mul_f32 v71, v71, v12
  s_waitcnt lgkmcnt(2)
  v_mfma_f32_32x32x16_bf16 v[112:127], v[28:31], v[208:211], v[112:127]
  v_cvt_pk_bf16_f32 v74, v68, v69
  v_cvt_pk_bf16_f32 v75, v70, v71
  ds_read_b64_tr_b16 v[36:37], v14 offset:2560
  ds_read_b64_tr_b16 v[38:39], v14 offset:2688
  s_add_u32 s54, s48, 1024
  s_lshr_b32 s59, s20, 2
  s_lshl_b32 s59, s59, 9
  s_and_b32 s56, s20, 3
  s_lshl_b32 s56, s56, 2
  s_add_u32 s59, s59, s56
  v_add_u32 v19, s59, v22
  s_mov_b64 exec, 0xffff
  v_cvt_pk_bf16_f32 v20, v128, v128
  v_lshlrev_b32 v20, 16, v20
  v_sub_f32 v144, v128, v20
  v_cvt_pk_bf16_f32 v128, v128, v144
  ds_write_b32 v19, v128 offset:3072
  v_cvt_pk_bf16_f32 v20, v129, v129
  v_lshlrev_b32 v20, 16, v20
  v_sub_f32 v144, v129, v20
  v_cvt_pk_bf16_f32 v129, v129, v144
  ds_write_b32 v19, v129 offset:3328
  v_cvt_pk_bf16_f32 v20, v132, v132
  v_lshlrev_b32 v20, 16, v20
  v_sub_f32 v144, v132, v20
  v_cvt_pk_bf16_f32 v132, v132, v144
  ds_write_b32 v19, v132 offset:4096
  v_cvt_pk_bf16_f32 v20, v133, v133
  v_lshlrev_b32 v20, 16, v20
  v_sub_f32 v144, v133, v20
  v_cvt_pk_bf16_f32 v133, v133, v144
  ds_write_b32 v19, v133 offset:4352
  s_mov_b64 exec, -1
  buffer_store_dwordx4 v[72:75], v22, s[16:19], s54 offen sc1
  v_mul_f32 v1, v80, v80
  s_waitcnt lgkmcnt(6)
  v_mfma_f32_32x32x16_bf16 v[96:111], v[32:35], v[212:215], v[96:111]
  v_mul_f32 v2, v81, v81
  ds_read_b64_tr_b16 v[24:25], v13 offset:6144
  ds_read_b64_tr_b16 v[26:27], v13 offset:6400
  v_mul_f32 v3, v82, v82
  v_mul_f32 v12, v83, v83
  s_waitcnt lgkmcnt(6)
  v_mfma_f32_32x32x16_bf16 v[112:127], v[36:39], v[212:215], v[112:127]
  v_fma_f32 v1, v1, v16, v15
  ds_read_b64_tr_b16 v[28:29], v14 offset:3072
  ds_read_b64_tr_b16 v[30:31], v14 offset:3200
  v_fma_f32 v2, v2, v16, v15
  v_fma_f32 v3, v3, v16, v15
  s_waitcnt lgkmcnt(2)
  v_mfma_f32_32x32x16_bf16 v[96:111], v[24:27], v[216:219], v[96:111]
  v_fma_f32 v12, v12, v16, v15
  ds_read_b64_tr_b16 v[32:33], v13 offset:7168
  ds_read_b64_tr_b16 v[34:35], v13 offset:7424
  v_mul_f32 v1, v1, v80
  v_mul_f32 v2, v2, v81
  s_waitcnt lgkmcnt(2)
  v_mfma_f32_32x32x16_bf16 v[112:127], v[28:31], v[216:219], v[112:127]
  v_mul_f32 v3, v3, v82
  v_mul_f32 v12, v12, v83
  ds_read_b64_tr_b16 v[36:37], v14 offset:3584
  ds_read_b64_tr_b16 v[38:39], v14 offset:3712
  v_exp_f32 v1, v1
  s_waitcnt lgkmcnt(2)
  v_mfma_f32_32x32x16_bf16 v[96:111], v[32:35], v[220:223], v[96:111]
  v_exp_f32 v2, v2
  v_exp_f32 v3, v3
  ds_read_b64_tr_b16 v[24:25], v21 offset:0
  ds_read_b64_tr_b16 v[26:27], v21 offset:256
  v_exp_f32 v12, v12
  s_waitcnt lgkmcnt(2)
  v_mfma_f32_32x32x16_bf16 v[112:127], v[36:39], v[220:223], v[112:127]
  v_mul_f32 v80, v80, v88
  v_mul_f32 v81, v81, v89
  ds_read_b64_tr_b16 v[28:29], v23 offset:0
  ds_read_b64_tr_b16 v[30:31], v23 offset:128
  v_mul_f32 v82, v82, v90
  s_barrier
  v_mul_f32 v83, v83, v91
  v_fma_f32 v1, v1, v17, v17
  s_waitcnt lgkmcnt(2)
  v_mfma_f32_32x32x16_bf16 v[96:111], v[24:27], v[224:227], v[96:111]
  v_fma_f32 v2, v2, v17, v17
  v_fma_f32 v3, v3, v17, v17
  ds_read_b64_tr_b16 v[32:33], v21 offset:1024
  ds_read_b64_tr_b16 v[34:35], v21 offset:1280
  v_fma_f32 v12, v12, v17, v17
  s_waitcnt lgkmcnt(2)
  v_mfma_f32_32x32x16_bf16 v[112:127], v[28:31], v[224:227], v[112:127]
  v_rcp_f32 v1, v1
  v_rcp_f32 v2, v2
  ds_read_b64_tr_b16 v[36:37], v23 offset:512
  ds_read_b64_tr_b16 v[38:39], v23 offset:640
  v_rcp_f32 v3, v3
  s_waitcnt lgkmcnt(2)
  v_mfma_f32_32x32x16_bf16 v[96:111], v[32:35], v[228:231], v[96:111]
  v_rcp_f32 v12, v12
  v_mul_f32 v80, v80, v1
  ds_read_b64_tr_b16 v[24:25], v21 offset:2048
  ds_read_b64_tr_b16 v[26:27], v21 offset:2304
  v_mul_f32 v81, v81, v2
  s_waitcnt lgkmcnt(2)
  v_mfma_f32_32x32x16_bf16 v[112:127], v[36:39], v[228:231], v[112:127]
  v_mul_f32 v82, v82, v3
  v_mul_f32 v83, v83, v12
  ds_read_b64_tr_b16 v[28:29], v23 offset:1024
  ds_read_b64_tr_b16 v[30:31], v23 offset:1152
  v_cvt_pk_bf16_f32 v88, v80, v81
  v_cvt_pk_bf16_f32 v89, v82, v83
  ds_read_b128 v[144:147], v22 offset:3072
  ds_read_b128 v[148:151], v22 offset:4096
  v_mul_f32 v1, v84, v84
  s_waitcnt lgkmcnt(4)
  v_mfma_f32_32x32x16_bf16 v[96:111], v[24:27], v[232:235], v[96:111]
  v_mul_f32 v2, v85, v85
  v_mul_f32 v3, v86, v86
  ds_read_b64_tr_b16 v[32:33], v21 offset:3072
  ds_read_b64_tr_b16 v[34:35], v21 offset:3328
  v_mul_f32 v12, v87, v87
  s_waitcnt lgkmcnt(4)
  v_mfma_f32_32x32x16_bf16 v[112:127], v[28:31], v[232:235], v[112:127]
  v_fma_f32 v1, v1, v16, v15
  v_fma_f32 v2, v2, v16, v15
  ds_read_b64_tr_b16 v[36:37], v23 offset:1536
  ds_read_b64_tr_b16 v[38:39], v23 offset:1664
  v_fma_f32 v3, v3, v16, v15
  s_waitcnt lgkmcnt(2)
  v_mfma_f32_32x32x16_bf16 v[96:111], v[32:35], v[236:239], v[96:111]
  v_fma_f32 v12, v12, v16, v15
  v_mul_f32 v1, v1, v84
  ds_read_b64_tr_b16 v[24:25], v21 offset:4096
  ds_read_b64_tr_b16 v[26:27], v21 offset:4352
  v_mul_f32 v2, v2, v85
  s_waitcnt lgkmcnt(2)
  v_mfma_f32_32x32x16_bf16 v[112:127], v[36:39], v[236:239], v[112:127]
  v_mul_f32 v3, v3, v86
  v_mul_f32 v12, v12, v87
  ds_read_b64_tr_b16 v[28:29], v23 offset:2048
  ds_read_b64_tr_b16 v[30:31], v23 offset:2176
  v_exp_f32 v1, v1
  v_exp_f32 v2, v2
  s_waitcnt lgkmcnt(2)
  v_mfma_f32_32x32x16_bf16 v[96:111], v[24:27], v[240:243], v[96:111]
  v_exp_f32 v3, v3
  ds_read_b64_tr_b16 v[32:33], v21 offset:5120
  ds_read_b64_tr_b16 v[34:35], v21 offset:5376
  v_exp_f32 v12, v12
  v_mul_f32 v84, v84, v92
  s_waitcnt lgkmcnt(2)
  v_mfma_f32_32x32x16_bf16 v[112:127], v[28:31], v[240:243], v[112:127]
  v_mul_f32 v85, v85, v93
  ds_read_b64_tr_b16 v[36:37], v23 offset:2560
  ds_read_b64_tr_b16 v[38:39], v23 offset:2688
  v_mul_f32 v86, v86, v94
  v_mul_f32 v87, v87, v95
  s_waitcnt lgkmcnt(2)
  v_mfma_f32_32x32x16_bf16 v[96:111], v[32:35], v[244:247], v[96:111]
  v_fma_f32 v1, v1, v17, v17
  ds_read_b64_tr_b16 v[24:25], v21 offset:6144
  ds_read_b64_tr_b16 v[26:27], v21 offset:6400
  v_fma_f32 v2, v2, v17, v17
  v_fma_f32 v3, v3, v17, v17
  s_waitcnt lgkmcnt(2)
  v_mfma_f32_32x32x16_bf16 v[112:127], v[36:39], v[244:247], v[112:127]
  v_fma_f32 v12, v12, v17, v17
  v_rcp_f32 v1, v1
  ds_read_b64_tr_b16 v[28:29], v23 offset:3072
  ds_read_b64_tr_b16 v[30:31], v23 offset:3200
  v_rcp_f32 v2, v2
  s_waitcnt lgkmcnt(2)
  v_mfma_f32_32x32x16_bf16 v[96:111], v[24:27], v[248:251], v[96:111]
  v_rcp_f32 v3, v3
  v_rcp_f32 v12, v12
  ds_read_b64_tr_b16 v[32:33], v21 offset:7168
  ds_read_b64_tr_b16 v[34:35], v21 offset:7424
  v_mul_f32 v84, v84, v1
  s_waitcnt lgkmcnt(2)
  v_mfma_f32_32x32x16_bf16 v[112:127], v[28:31], v[248:251], v[112:127]
  v_mul_f32 v85, v85, v2
  v_mul_f32 v86, v86, v3
  ds_read_b64_tr_b16 v[36:37], v23 offset:3584
  ds_read_b64_tr_b16 v[38:39], v23 offset:3712
  v_mul_f32 v87, v87, v12
  s_waitcnt lgkmcnt(2)
  v_mfma_f32_32x32x16_bf16 v[96:111], v[32:35], v[252:255], v[96:111]
  v_cvt_pk_bf16_f32 v90, v84, v85
  v_cvt_pk_bf16_f32 v91, v86, v87
  s_waitcnt lgkmcnt(0)
  v_mfma_f32_32x32x16_bf16 v[112:127], v[36:39], v[252:255], v[112:127]
  s_add_u32 s54, s48, 2048
  buffer_store_dwordx4 v[88:91], v22, s[16:19], s54 offen sc1
  v_mfma_f32_32x32x16_bf16 v[96:111], v[144:147], v[4:7], v[96:111]
  v_mfma_f32_32x32x16_bf16 v[112:127], v[148:151], v[4:7], v[112:127]
  v_mul_f32 v1, s51, v18
  s_nop 9
  v_mul_f32 v96, v96, v1
  v_mul_f32 v97, v97, v1
  v_mul_f32 v98, v98, v1
  v_mul_f32 v99, v99, v1
  v_mul_f32 v100, v100, v1
  v_mul_f32 v101, v101, v1
  v_mul_f32 v102, v102, v1
  v_mul_f32 v103, v103, v1
  v_mul_f32 v104, v104, v1
  v_mul_f32 v105, v105, v1
  v_mul_f32 v106, v106, v1
  v_mul_f32 v107, v107, v1
  v_mul_f32 v108, v108, v1
  v_mul_f32 v109, v109, v1
  v_mul_f32 v110, v110, v1
  v_mul_f32 v111, v111, v1
  v_cvt_pk_bf16_f32 v160, v96, v97
  v_cvt_pk_bf16_f32 v161, v98, v99
  v_cvt_pk_bf16_f32 v162, v100, v101
  v_cvt_pk_bf16_f32 v163, v102, v103
  v_cvt_pk_bf16_f32 v164, v104, v105
  v_cvt_pk_bf16_f32 v165, v106, v107
  v_cvt_pk_bf16_f32 v166, v108, v109
  v_cvt_pk_bf16_f32 v167, v110, v111
  s_add_u32 s54, s49, 65536
  buffer_store_dwordx4 v[160:163], v22, s[16:19], s49 offen sc1
  buffer_store_dwordx4 v[164:167], v22, s[16:19], s54 offen sc1
  v_mul_f32 v1, v112, v112
  v_mul_f32 v2, v113, v113
  v_mul_f32 v3, v114, v114
  v_mul_f32 v12, v115, v115
  v_fma_f32 v1, v1, v16, v15
  v_fma_f32 v2, v2, v16, v15
  v_fma_f32 v3, v3, v16, v15
  v_fma_f32 v12, v12, v16, v15
  v_mul_f32 v1, v1, v112
  v_mul_f32 v2, v2, v113
  v_mul_f32 v3, v3, v114
  v_mul_f32 v12, v12, v115
  v_exp_f32 v1, v1
  v_exp_f32 v2, v2
  v_exp_f32 v3, v3
  v_exp_f32 v12, v12
  v_mul_f32 v112, v112, v120
  v_mul_f32 v113, v113, v121
  v_mul_f32 v114, v114, v122
  v_mul_f32 v115, v115, v123
  v_fma_f32 v1, v1, v17, v17
  v_fma_f32 v2, v2, v17, v17
  v_fma_f32 v3, v3, v17, v17
  v_fma_f32 v12, v12, v17, v17
  v_rcp_f32 v1, v1
  v_rcp_f32 v2, v2
  v_rcp_f32 v3, v3
  v_rcp_f32 v12, v12
  v_mul_f32 v112, v112, v1
  v_mul_f32 v113, v113, v2
  v_mul_f32 v114, v114, v3
  v_mul_f32 v115, v115, v12
  v_cvt_pk_bf16_f32 v120, v112, v113
  v_cvt_pk_bf16_f32 v121, v114, v115
  v_mul_f32 v1, v116, v116
  v_mul_f32 v2, v117, v117
  v_mul_f32 v3, v118, v118
  v_mul_f32 v12, v119, v119
  v_fma_f32 v1, v1, v16, v15
  v_fma_f32 v2, v2, v16, v15
  v_fma_f32 v3, v3, v16, v15
  v_fma_f32 v12, v12, v16, v15
  v_mul_f32 v1, v1, v116
  v_mul_f32 v2, v2, v117
  v_mul_f32 v3, v3, v118
  v_mul_f32 v12, v12, v119
  v_exp_f32 v1, v1
  v_exp_f32 v2, v2
  v_exp_f32 v3, v3
  v_exp_f32 v12, v12
  v_mul_f32 v116, v116, v124
  v_mul_f32 v117, v117, v125
  v_mul_f32 v118, v118, v126
  v_mul_f32 v119, v119, v127
  v_fma_f32 v1, v1, v17, v17
  v_fma_f32 v2, v2, v17, v17
  v_fma_f32 v3, v3, v17, v17
  v_fma_f32 v12, v12, v17, v17
  v_rcp_f32 v1, v1
  v_rcp_f32 v2, v2
  v_rcp_f32 v3, v3
  v_rcp_f32 v12, v12
  v_mul_f32 v116, v116, v1
  v_mul_f32 v117, v117, v2
  v_mul_f32 v118, v118, v3
  v_mul_f32 v119, v119, v12
  v_cvt_pk_bf16_f32 v122, v116, v117
  v_cvt_pk_bf16_f32 v123, v118, v119
  s_add_u32 s54, s50, 0
  buffer_store_dwordx4 v[120:123], v22, s[16:19], s54 offen sc1
K1_END:
  s_endpgm
.text
.globl k2_kernel
.p2align 8
.type k2_kernel,@function
k2_kernel:
  s_cmp_ge_u32 s2, 256
  s_cbranch_scc1 K2_END
  s_load_dwordx2 s[4:5], s[0:1], 0
  s_load_dwordx2 s[8:9], s[0:1], 16
  s_load_dwordx2 s[12:13], s[0:1], 48
  s_load_dwordx4 s[24:27], s[0:1], 56
  s_load_dwordx2 s[16:17], s[0:1], 72
  v_mov_b32 v15, v0
  v_lshrrev_b32 v1, 6, v0
  v_and_b32 v0, 63, v0
  v_readfirstlane_b32 s20, v1
  s_and_b32 s36, s2, 7
  s_lshr_b32 s37, s2, 3
  s_lshl_b32 s21, s36, 2
  s_lshr_b32 s38, s37, 3
  s_add_u32 s21, s21, s38
  s_and_b32 s22, s37, 7
  v_lshlrev_b32 v14, 4, v0
  v_lshrrev_b32 v1, 3, v15
  v_and_b32 v2, 7, v15
  v_lshlrev_b32 v13, 10, v1
  v_lshl_add_u32 v13, v2, 4, v13
  v_mul_u32_u24 v12, 272, v1
  v_lshl_add_u32 v12, v2, 5, v12
  s_lshl_b32 s23, s21, 16
  s_lshl_b32 s36, s22, 7
  s_add_u32 s23, s23, s36
  v_mov_b32 v1, 0
  v_mov_b32 v2, 69632
  v_and_b32 v3, 7, v0
  v_lshl_add_u32 v2, v3, 2, v2
  ds_write_b32 v2, v1
  s_waitcnt lgkmcnt(0)
  s_mov_b32 s6, 0x200000
  s_mov_b32 s7, 0x20000
  s_mov_b32 s10, 0x80000
  s_mov_b32 s11, 0x20000
  s_mov_b32 s14, 1835008
  s_mov_b32 s15, 0x20000
  s_mov_b32 s18, 33554432
  s_mov_b32 s19, 0x20000
  s_mov_b32 s28, s24
  s_mov_b32 s29, s25
  s_mov_b32 s30, 0x200000
  s_mov_b32 s31, 0x20000
  s_mov_b32 s32, s26
  s_mov_b32 s33, s27
  s_mov_b32 s34, 256
  s_mov_b32 s35, 0x20000
  s_barrier
  s_cmp_ge_u32 s20, 4
  s_cbranch_scc1 K2_ATT
  v_lshrrev_b32 v1, 3, v0
  v_and_b32 v2, 7, v0
  v_bfe_u32 v3, v0, 4, 1
  v_lshlrev_b32 v3, 2, v3
  v_xor_b32 v2, v2, v3
  v_lshlrev_b32 v1, 10, v1
  v_lshl_add_u32 v1, v2, 4, v1
  v_lshrrev_b32 v2, 5, v0
  v_bfe_u32 v3, v0, 2, 2
  v_lshl_add_u32 v2, v2, 2, v3
  v_lshlrev_b32 v2, 7, v2
  v_lshrrev_b32 v3, 1, v3
  v_lshl_add_u32 v2, v3, 6, v2
  v_bfe_u32 v3, v0, 4, 1
  v_lshl_add_u32 v2, v3, 5, v2
  v_and_b32 v3, 3, v0
  v_lshl_add_u32 v2, v3, 3, v2
  s_mul_i32 s40, s20, 17408
  v_add_u32 v2, s40, v2
  v_xor_b32 v3, 64, v2
  s_mul_i32 s41, s21, 224
  s_mul_i32 s36, s20, 28
  s_add_u32 s41, s41, s36
  s_lshl_b32 s41, s41, 10
  s_add_u32 s41, s41, 6291456
  s_add_u32 s42, s41, 114688
  s_mul_i32 s43, s20, 458752
  s_lshl_b32 s36, s22, 7
  s_add_u32 s43, s43, s36
  s_lshl_b32 s44, s21, 6
  s_lshl_b32 s37, s20, 3
  s_add_u32 s44, s44, s37
  s_lshl_b32 s44, s44, 10
  s_add_u32 s44, s44, 14680064
  s_add_u32 s45, s44, 32768
  s_lshl_b32 s46, s20, 17
  s_add_u32 s46, s46, s36
  v_mov_b32 v4, 69632
  s_add_u32 s51, s43, 0
  s_add_u32 m0, s40, 0
  s_nop 0
  buffer_load_dwordx4 v1, s[12:15], s51 offen lds
  s_add_u32 s51, s43, 8192
  s_add_u32 m0, s40, 1024
  s_nop 0
  buffer_load_dwordx4 v1, s[12:15], s51 offen lds
  s_add_u32 s50, s41, 0
  buffer_load_dwordx4 v[16:19], v14, s[16:19], s50 offen
  s_add_u32 s50, s42, 0
  buffer_load_dwordx4 v[20:23], v14, s[16:19], s50 offen
  s_add_u32 s51, s43, 16384
  s_add_u32 m0, s40, 2048
  s_nop 0
  buffer_load_dwordx4 v1, s[12:15], s51 offen lds
  s_add_u32 s51, s43, 24576
  s_add_u32 m0, s40, 3072
  s_nop 0
  buffer_load_dwordx4 v1, s[12:15], s51 offen lds
  s_add_u32 s50, s41, 1024
  buffer_load_dwordx4 v[24:27], v14, s[16:19], s50 offen
  s_add_u32 s50, s42, 1024
  buffer_load_dwordx4 v[28:31], v14, s[16:19], s50 offen
  s_add_u32 s51, s43, 32768
  s_add_u32 m0, s40, 4096
  s_nop 0
  buffer_load_dwordx4 v1, s[12:15], s51 offen lds
  s_add_u32 s51, s43, 40960
  s_add_u32 m0, s40, 5120
  s_nop 0
  buffer_load_dwordx4 v1, s[12:15], s51 offen lds
  s_add_u32 s50, s41, 2048
  buffer_load_dwordx4 v[32:35], v14, s[16:19], s50 offen
  s_add_u32 s50, s42, 2048
  buffer_load_dwordx4 v[36:39], v14, s[16:19], s50 offen
  s_add_u32 s51, s43, 49152
  s_add_u32 m0, s40, 6144
  s_nop 0
  buffer_load_dwordx4 v1, s[12:15], s51 offen lds
  s_add_u32 s51, s43, 57344
  s_add_u32 m0, s40, 7168
  s_nop 0
  buffer_load_dwordx4 v1, s[12:15], s51 offen lds
  s_add_u32 s50, s41, 3072
  buffer_load_dwordx4 v[40:43], v14, s[16:19], s50 offen
  s_add_u32 s50, s42, 3072
  buffer_load_dwordx4 v[44:47], v14, s[16:19], s50 offen
  s_add_u32 s51, s43, 65536
  s_add_u32 m0, s40, 8192
  s_nop 0
  buffer_load_dwordx4 v1, s[12:15], s51 offen lds
  s_add_u32 s51, s43, 73728
  s_add_u32 m0, s40, 9216
  s_nop 0
  buffer_load_dwordx4 v1, s[12:15], s51 offen lds
  s_add_u32 s50, s41, 4096
  buffer_load_dwordx4 v[48:51], v14, s[16:19], s50 offen
  s_add_u32 s50, s42, 4096
  buffer_load_dwordx4 v[52:55], v14, s[16:19], s50 offen
  s_add_u32 s51, s43, 81920
  s_add_u32 m0, s40, 10240
  s_nop 0
  buffer_load_dwordx4 v1, s[12:15], s51 offen lds
  s_add_u32 s51, s43, 90112
  s_add_u32 m0, s40, 11264
  s_nop 0
  buffer_load_dwordx4 v1, s[12:15], s51 offen lds
  s_add_u32 s50, s41, 5120
  buffer_load_dwordx4 v[56:59], v14, s[16:19], s50 offen
  s_add_u32 s50, s42, 5120
  buffer_load_dwordx4 v[60:63], v14, s[16:19], s50 offen
  s_add_u32 s51, s43, 98304
  s_add_u32 m0, s40, 12288
  s_nop 0
  buffer_load_dwordx4 v1, s[12:15], s51 offen lds
  s_add_u32 s51, s43, 106496
  s_add_u32 m0, s40, 13312
  s_nop 0
  buffer_load_dwordx4 v1, s[12:15], s51 offen lds
  s_add_u32 s50, s41, 6144
  buffer_load_dwordx4 v[64:67], v14, s[16:19], s50 offen
  s_add_u32 s50, s42, 6144
  buffer_load_dwordx4 v[68:71], v14, s[16:19], s50 offen
  s_add_u32 s51, s43, 114688
  s_add_u32 m0, s40, 14336
  s_nop 0
  buffer_load_dwordx4 v1, s[12:15], s51 offen lds
  s_add_u32 s51, s43, 122880
  s_add_u32 m0, s40, 15360
  s_nop 0
  buffer_load_dwordx4 v1, s[12:15], s51 offen lds
  s_add_u32 s50, s41, 7168
  buffer_load_dwordx4 v[72:75], v14, s[16:19], s50 offen
  s_add_u32 s50, s42, 7168
  buffer_load_dwordx4 v[76:79], v14, s[16:19], s50 offen
  buffer_load_dwordx4 v[232:235], v13, s[4:7], s23 offen
  s_waitcnt vmcnt(31)
  ds_read_b64_tr_b16 v[80:81], v2 offset:0
  ds_read_b64_tr_b16 v[82:83], v2 offset:1024
  ds_read_b64_tr_b16 v[84:85], v3 offset:0
  ds_read_b64_tr_b16 v[86:87], v3 offset:1024
  s_waitcnt vmcnt(29) lgkmcnt(0)
  v_mfma_f32_32x32x16_bf16 v[96:111], v[80:83], v[16:19], 0
  v_mfma_f32_32x32x16_bf16 v[112:127], v[84:87], v[16:19], 0
  s_waitcnt vmcnt(27)
  ds_read_b64_tr_b16 v[88:89], v2 offset:2048
  ds_read_b64_tr_b16 v[90:91], v2 offset:3072
  ds_read_b64_tr_b16 v[92:93], v3 offset:2048
  ds_read_b64_tr_b16 v[94:95], v3 offset:3072
  v_mfma_f32_32x32x16_bf16 v[128:143], v[80:83], v[20:23], 0
  v_mfma_f32_32x32x16_bf16 v[144:159], v[84:87], v[20:23], 0
  s_add_u32 s51, s43, 131072
  s_add_u32 m0, s40, 0
  s_nop 0
  buffer_load_dwordx4 v1, s[12:15], s51 offen lds
  s_add_u32 s51, s43, 139264
  s_add_u32 m0, s40, 1024
  s_nop 0
  buffer_load_dwordx4 v1, s[12:15], s51 offen lds
  s_waitcnt vmcnt(27) lgkmcnt(0)
  v_mfma_f32_32x32x16_bf16 v[96:111], v[88:91], v[24:27], v[96:111]
  v_mfma_f32_32x32x16_bf16 v[112:127], v[92:95], v[24:27], v[112:127]
  s_waitcnt vmcnt(25)
  ds_read_b64_tr_b16 v[80:81], v2 offset:4096
  ds_read_b64_tr_b16 v[82:83], v2 offset:5120
  ds_read_b64_tr_b16 v[84:85], v3 offset:4096
  ds_read_b64_tr_b16 v[86:87], v3 offset:5120
  v_mfma_f32_32x32x16_bf16 v[128:143], v[88:91], v[28:31], v[128:143]
  v_mfma_f32_32x32x16_bf16 v[144:159], v[92:95], v[28:31], v[144:159]
  s_add_u32 s51, s43, 147456
  s_add_u32 m0, s40, 2048
  s_nop 0
  buffer_load_dwordx4 v1, s[12:15], s51 offen lds
  s_add_u32 s51, s43, 155648
  s_add_u32 m0, s40, 3072
  s_nop 0
  buffer_load_dwordx4 v1, s[12:15], s51 offen lds
  s_add_u32 s50, s41, 8192
  buffer_load_dwordx4 v[16:19], v14, s[16:19], s50 offen
  s_add_u32 s50, s42, 8192
  buffer_load_dwordx4 v[20:23], v14, s[16:19], s50 offen
  s_waitcnt vmcnt(27) lgkmcnt(0)
  v_mfma_f32_32x32x16_bf16 v[96:111], v[80:83], v[32:35], v[96:111]
  v_mfma_f32_32x32x16_bf16 v[112:127], v[84:87], v[32:35], v[112:127]
  s_waitcnt vmcnt(25)
  ds_read_b64_tr_b16 v[88:89], v2 offset:6144
  ds_read_b64_tr_b16 v[90:91], v2 offset:7168
  ds_read_b64_tr_b16 v[92:93], v3 offset:6144
  ds_read_b64_tr_b16 v[94:95], v3 offset:7168
  v_mfma_f32_32x32x16_bf16 v[128:143], v[80:83], v[36:39], v[128:143]
  v_mfma_f32_32x32x16_bf16 v[144:159], v[84:87], v[36:39], v[144:159]
  s_add_u32 s51, s43, 163840
  s_add_u32 m0, s40, 4096
  s_nop 0
  buffer_load_dwordx4 v1, s[12:15], s51 offen lds
  s_add_u32 s51, s43, 172032
  s_add_u32 m0, s40, 5120
  s_nop 0
  buffer_load_dwordx4 v1, s[12:15], s51 offen lds
  s_add_u32 s50, s41, 9216
  buffer_load_dwordx4 v[24:27], v14, s[16:19], s50 offen
  s_add_u32 s50, s42, 9216
  buffer_load_dwordx4 v[28:31], v14, s[16:19], s50 offen
  s_waitcnt vmcnt(27) lgkmcnt(0)
  v_mfma_f32_32x32x16_bf16 v[96:111], v[88:91], v[40:43], v[96:111]
  v_mfma_f32_32x32x16_bf16 v[112:127], v[92:95], v[40:43], v[112:127]
  s_waitcnt vmcnt(25)
  ds_read_b64_tr_b16 v[80:81], v2 offset:8192
  ds_read_b64_tr_b16 v[82:83], v2 offset:9216
  ds_read_b64_tr_b16 v[84:85], v3 offset:8192
  ds_read_b64_tr_b16 v[86:87], v3 offset:9216
  v_mfma_f32_32x32x16_bf16 v[128:143], v[88:91], v[44:47], v[128:143]
  v_mfma_f32_32x32x16_bf16 v[144:159], v[92:95], v[44:47], v[144:159]
  s_add_u32 s51, s43, 180224
  s_add_u32 m0, s40, 6144
  s_nop 0
  buffer_load_dwordx4 v1, s[12:15], s51 offen lds
  s_add_u32 s51, s43, 188416
  s_add_u32 m0, s40, 7168
  s_nop 0
  buffer_load_dwordx4 v1, s[12:15], s51 offen lds
  s_add_u32 s50, s41, 10240
  buffer_load_dwordx4 v[32:35], v14, s[16:19], s50 offen
  s_add_u32 s50, s42, 10240
  buffer_load_dwordx4 v[36:39], v14, s[16:19], s50 offen
  s_waitcnt vmcnt(27) lgkmcnt(0)
  v_mfma_f32_32x32x16_bf16 v[96:111], v[80:83], v[48:51], v[96:111]
  v_mfma_f32_32x32x16_bf16 v[112:127], v[84:87], v[48:51], v[112:127]
  s_waitcnt vmcnt(25)
  ds_read_b64_tr_b16 v[88:89], v2 offset:10240
  ds_read_b64_tr_b16 v[90:91], v2 offset:11264
  ds_read_b64_tr_b16 v[92:93], v3 offset:10240
  ds_read_b64_tr_b16 v[94:95], v3 offset:11264
  v_mfma_f32_32x32x16_bf16 v[128:143], v[80:83], v[52:55], v[128:143]
  v_mfma_f32_32x32x16_bf16 v[144:159], v[84:87], v[52:55], v[144:159]
  s_add_u32 s51, s43, 196608
  s_add_u32 m0, s40, 8192
  s_nop 0
  buffer_load_dwordx4 v1, s[12:15], s51 offen lds
  s_add_u32 s51, s43, 204800
  s_add_u32 m0, s40, 9216
  s_nop 0
  buffer_load_dwordx4 v1, s[12:15], s51 offen lds
  s_add_u32 s50, s41, 11264
  buffer_load_dwordx4 v[40:43], v14, s[16:19], s50 offen
  s_add_u32 s50, s42, 11264
  buffer_load_dwordx4 v[44:47], v14, s[16:19], s50 offen
  s_waitcnt vmcnt(27) lgkmcnt(0)
  v_mfma_f32_32x32x16_bf16 v[96:111], v[88:91], v[56:59], v[96:111]
  v_mfma_f32_32x32x16_bf16 v[112:127], v[92:95], v[56:59], v[112:127]
  s_waitcnt vmcnt(25)
  ds_read_b64_tr_b16 v[80:81], v2 offset:12288
  ds_read_b64_tr_b16 v[82:83], v2 offset:13312
  ds_read_b64_tr_b16 v[84:85], v3 offset:12288
  ds_read_b64_tr_b16 v[86:87], v3 offset:13312
  v_mfma_f32_32x32x16_bf16 v[128:143], v[88:91], v[60:63], v[128:143]
  v_mfma_f32_32x32x16_bf16 v[144:159], v[92:95], v[60:63], v[144:159]
  s_add_u32 s51, s43, 212992
  s_add_u32 m0, s40, 10240
  s_nop 0
  buffer_load_dwordx4 v1, s[12:15], s51 offen lds
  s_add_u32 s51, s43, 221184
  s_add_u32 m0, s40, 11264
  s_nop 0
  buffer_load_dwordx4 v1, s[12:15], s51 offen lds
  s_add_u32 s50, s41, 12288
  buffer_load_dwordx4 v[48:51], v14, s[16:19], s50 offen
  s_add_u32 s50, s42, 12288
  buffer_load_dwordx4 v[52:55], v14, s[16:19], s50 offen
  s_waitcnt vmcnt(27) lgkmcnt(0)
  v_mfma_f32_32x32x16_bf16 v[96:111], v[80:83], v[64:67], v[96:111]
  v_mfma_f32_32x32x16_bf16 v[112:127], v[84:87], v[64:67], v[112:127]
  s_waitcnt vmcnt(25)
  ds_read_b64_tr_b16 v[88:89], v2 offset:14336
  ds_read_b64_tr_b16 v[90:91], v2 offset:15360
  ds_read_b64_tr_b16 v[92:93], v3 offset:14336
  ds_read_b64_tr_b16 v[94:95], v3 offset:15360
  v_mfma_f32_32x32x16_bf16 v[128:143], v[80:83], v[68:71], v[128:143]
  v_mfma_f32_32x32x16_bf16 v[144:159], v[84:87], v[68:71], v[144:159]
  s_add_u32 s51, s43, 229376
  s_add_u32 m0, s40, 12288
  s_nop 0
  buffer_load_dwordx4 v1, s[12:15], s51 offen lds
  s_add_u32 s51, s43, 237568
  s_add_u32 m0, s40, 13312
  s_nop 0
  buffer_load_dwordx4 v1, s[12:15], s51 offen lds
  s_add_u32 s50, s41, 13312
  buffer_load_dwordx4 v[56:59], v14, s[16:19], s50 offen
  s_add_u32 s50, s42, 13312
  buffer_load_dwordx4 v[60:63], v14, s[16:19], s50 offen
  s_waitcnt vmcnt(27) lgkmcnt(0)
  v_mfma_f32_32x32x16_bf16 v[96:111], v[88:91], v[72:75], v[96:111]
  v_mfma_f32_32x32x16_bf16 v[112:127], v[92:95], v[72:75], v[112:127]
  s_waitcnt vmcnt(24)
  ds_read_b64_tr_b16 v[80:81], v2 offset:0
  ds_read_b64_tr_b16 v[82:83], v2 offset:1024
  ds_read_b64_tr_b16 v[84:85], v3 offset:0
  ds_read_b64_tr_b16 v[86:87], v3 offset:1024
  v_mfma_f32_32x32x16_bf16 v[128:143], v[88:91], v[76:79], v[128:143]
  v_mfma_f32_32x32x16_bf16 v[144:159], v[92:95], v[76:79], v[144:159]
  s_add_u32 s51, s43, 245760
  s_add_u32 m0, s40, 14336
  s_nop 0
  buffer_load_dwordx4 v1, s[12:15], s51 offen lds
  s_add_u32 s51, s43, 253952
  s_add_u32 m0, s40, 15360
  s_nop 0
  buffer_load_dwordx4 v1, s[12:15], s51 offen lds
  s_add_u32 s50, s41, 14336
  buffer_load_dwordx4 v[64:67], v14, s[16:19], s50 offen
  s_add_u32 s50, s42, 14336
  buffer_load_dwordx4 v[68:71], v14, s[16:19], s50 offen
  s_waitcnt vmcnt(24) lgkmcnt(0)
  v_mfma_f32_32x32x16_bf16 v[96:111], v[80:83], v[16:19], v[96:111]
  v_mfma_f32_32x32x16_bf16 v[112:127], v[84:87], v[16:19], v[112:127]
  ds_read_b64_tr_b16 v[88:89], v2 offset:2048
  ds_read_b64_tr_b16 v[90:91], v2 offset:3072
  ds_read_b64_tr_b16 v[92:93], v3 offset:2048
  ds_read_b64_tr_b16 v[94:95], v3 offset:3072
  v_mfma_f32_32x32x16_bf16 v[128:143], v[80:83], v[20:23], v[128:143]
  v_mfma_f32_32x32x16_bf16 v[144:159], v[84:87], v[20:23], v[144:159]
  s_add_u32 s51, s43, 262144
  s_add_u32 m0, s40, 0
  s_nop 0
  buffer_load_dwordx4 v1, s[12:15], s51 offen lds
  s_add_u32 s51, s43, 270336
  s_add_u32 m0, s40, 1024
  s_nop 0
  buffer_load_dwordx4 v1, s[12:15], s51 offen lds
  s_add_u32 s50, s41, 15360
  buffer_load_dwordx4 v[72:75], v14, s[16:19], s50 offen
  s_add_u32 s50, s42, 15360
  buffer_load_dwordx4 v[76:79], v14, s[16:19], s50 offen
  s_waitcnt vmcnt(24) lgkmcnt(0)
  v_mfma_f32_32x32x16_bf16 v[96:111], v[88:91], v[24:27], v[96:111]
  v_mfma_f32_32x32x16_bf16 v[112:127], v[92:95], v[24:27], v[112:127]
  ds_read_b64_tr_b16 v[80:81], v2 offset:4096
  ds_read_b64_tr_b16 v[82:83], v2 offset:5120
  ds_read_b64_tr_b16 v[84:85], v3 offset:4096
  ds_read_b64_tr_b16 v[86:87], v3 offset:5120
  v_mfma_f32_32x32x16_bf16 v[128:143], v[88:91], v[28:31], v[128:143]
  v_mfma_f32_32x32x16_bf16 v[144:159], v[92:95], v[28:31], v[144:159]
  s_add_u32 s51, s43, 278528
  s_add_u32 m0, s40, 2048
  s_nop 0
  buffer_load_dwordx4 v1, s[12:15], s51 offen lds
  s_add_u32 s51, s43, 286720
  s_add_u32 m0, s40, 3072
  s_nop 0
  buffer_load_dwordx4 v1, s[12:15], s51 offen lds
  s_add_u32 s50, s41, 16384
  buffer_load_dwordx4 v[16:19], v14, s[16:19], s50 offen
  s_add_u32 s50, s42, 16384
  buffer_load_dwordx4 v[20:23], v14, s[16:19], s50 offen
  s_waitcnt vmcnt(24) lgkmcnt(0)
  v_mfma_f32_32x32x16_bf16 v[96:111], v[80:83], v[32:35], v[96:111]
  v_mfma_f32_32x32x16_bf16 v[112:127], v[84:87], v[32:35], v[112:127]
  ds_read_b64_tr_b16 v[88:89], v2 offset:6144
  ds_read_b64_tr_b16 v[90:91], v2 offset:7168
  ds_read_b64_tr_b16 v[92:93], v3 offset:6144
  ds_read_b64_tr_b16 v[94:95], v3 offset:7168
  v_mfma_f32_32x32x16_bf16 v[128:143], v[80:83], v[36:39], v[128:143]
  v_mfma_f32_32x32x16_bf16 v[144:159], v[84:87], v[36:39], v[144:159]
  s_add_u32 s51, s43, 294912
  s_add_u32 m0, s40, 4096
  s_nop 0
  buffer_load_dwordx4 v1, s[12:15], s51 offen lds
  s_add_u32 s51, s43, 303104
  s_add_u32 m0, s40, 5120
  s_nop 0
  buffer_load_dwordx4 v1, s[12:15], s51 offen lds
  s_add_u32 s50, s41, 17408
  buffer_load_dwordx4 v[24:27], v14, s[16:19], s50 offen
  s_add_u32 s50, s42, 17408
  buffer_load_dwordx4 v[28:31], v14, s[16:19], s50 offen
  s_waitcnt vmcnt(24) lgkmcnt(0)
  v_mfma_f32_32x32x16_bf16 v[96:111], v[88:91], v[40:43], v[96:111]
  v_mfma_f32_32x32x16_bf16 v[112:127], v[92:95], v[40:43], v[112:127]
  ds_read_b64_tr_b16 v[80:81], v2 offset:8192
  ds_read_b64_tr_b16 v[82:83], v2 offset:9216
  ds_read_b64_tr_b16 v[84:85], v3 offset:8192
  ds_read_b64_tr_b16 v[86:87], v3 offset:9216
  v_mfma_f32_32x32x16_bf16 v[128:143], v[88:91], v[44:47], v[128:143]
  v_mfma_f32_32x32x16_bf16 v[144:159], v[92:95], v[44:47], v[144:159]
  s_add_u32 s51, s43, 311296
  s_add_u32 m0, s40, 6144
  s_nop 0
  buffer_load_dwordx4 v1, s[12:15], s51 offen lds
  s_add_u32 s51, s43, 319488
  s_add_u32 m0, s40, 7168
  s_nop 0
  buffer_load_dwordx4 v1, s[12:15], s51 offen lds
  s_add_u32 s50, s41, 18432
  buffer_load_dwordx4 v[32:35], v14, s[16:19], s50 offen
  s_add_u32 s50, s42, 18432
  buffer_load_dwordx4 v[36:39], v14, s[16:19], s50 offen
  s_waitcnt vmcnt(24) lgkmcnt(0)
  v_mfma_f32_32x32x16_bf16 v[96:111], v[80:83], v[48:51], v[96:111]
  v_mfma_f32_32x32x16_bf16 v[112:127], v[84:87], v[48:51], v[112:127]
  ds_read_b64_tr_b16 v[88:89], v2 offset:10240
  ds_read_b64_tr_b16 v[90:91], v2 offset:11264
  ds_read_b64_tr_b16 v[92:93], v3 offset:10240
  ds_read_b64_tr_b16 v[94:95], v3 offset:11264
  v_mfma_f32_32x32x16_bf16 v[128:143], v[80:83], v[52:55], v[128:143]
  v_mfma_f32_32x32x16_bf16 v[144:159], v[84:87], v[52:55], v[144:159]
  s_add_u32 s51, s43, 327680
  s_add_u32 m0, s40, 8192
  s_nop 0
  buffer_load_dwordx4 v1, s[12:15], s51 offen lds
  s_add_u32 s51, s43, 335872
  s_add_u32 m0, s40, 9216
  s_nop 0
  buffer_load_dwordx4 v1, s[12:15], s51 offen lds
  s_add_u32 s50, s41, 19456
  buffer_load_dwordx4 v[40:43], v14, s[16:19], s50 offen
  s_add_u32 s50, s42, 19456
  buffer_load_dwordx4 v[44:47], v14, s[16:19], s50 offen
  s_waitcnt vmcnt(24) lgkmcnt(0)
  v_mfma_f32_32x32x16_bf16 v[96:111], v[88:91], v[56:59], v[96:111]
  v_mfma_f32_32x32x16_bf16 v[112:127], v[92:95], v[56:59], v[112:127]
  ds_read_b64_tr_b16 v[80:81], v2 offset:12288
  ds_read_b64_tr_b16 v[82:83], v2 offset:13312
  ds_read_b64_tr_b16 v[84:85], v3 offset:12288
  ds_read_b64_tr_b16 v[86:87], v3 offset:13312
  v_mfma_f32_32x32x16_bf16 v[128:143], v[88:91], v[60:63], v[128:143]
  v_mfma_f32_32x32x16_bf16 v[144:159], v[92:95], v[60:63], v[144:159]
  s_add_u32 s51, s43, 344064
  s_add_u32 m0, s40, 10240
  s_nop 0
  buffer_load_dwordx4 v1, s[12:15], s51 offen lds
  s_add_u32 s51, s43, 352256
  s_add_u32 m0, s40, 11264
  s_nop 0
  buffer_load_dwordx4 v1, s[12:15], s51 offen lds
  s_add_u32 s50, s41, 20480
  buffer_load_dwordx4 v[48:51], v14, s[16:19], s50 offen
  s_add_u32 s50, s42, 20480
  buffer_load_dwordx4 v[52:55], v14, s[16:19], s50 offen
  s_waitcnt vmcnt(24) lgkmcnt(0)
  v_mfma_f32_32x32x16_bf16 v[96:111], v[80:83], v[64:67], v[96:111]
  v_mfma_f32_32x32x16_bf16 v[112:127], v[84:87], v[64:67], v[112:127]
  ds_read_b64_tr_b16 v[88:89], v2 offset:14336
  ds_read_b64_tr_b16 v[90:91], v2 offset:15360
  ds_read_b64_tr_b16 v[92:93], v3 offset:14336
  ds_read_b64_tr_b16 v[94:95], v3 offset:15360
  v_mfma_f32_32x32x16_bf16 v[128:143], v[80:83], v[68:71], v[128:143]
  v_mfma_f32_32x32x16_bf16 v[144:159], v[84:87], v[68:71], v[144:159]
  s_add_u32 s51, s43, 360448
  s_add_u32 m0, s40, 12288
  s_nop 0
  buffer_load_dwordx4 v1, s[12:15], s51 offen lds
  s_add_u32 s51, s43, 368640
  s_add_u32 m0, s40, 13312
  s_nop 0
  buffer_load_dwordx4 v1, s[12:15], s51 offen lds
  s_add_u32 s50, s41, 21504
  buffer_load_dwordx4 v[56:59], v14, s[16:19], s50 offen
  s_add_u32 s50, s42, 21504
  buffer_load_dwordx4 v[60:63], v14, s[16:19], s50 offen
  s_waitcnt vmcnt(24) lgkmcnt(0)
  v_mfma_f32_32x32x16_bf16 v[96:111], v[88:91], v[72:75], v[96:111]
  v_mfma_f32_32x32x16_bf16 v[112:127], v[92:95], v[72:75], v[112:127]
  ds_read_b64_tr_b16 v[80:81], v2 offset:0
  ds_read_b64_tr_b16 v[82:83], v2 offset:1024
  ds_read_b64_tr_b16 v[84:85], v3 offset:0
  ds_read_b64_tr_b16 v[86:87], v3 offset:1024
  v_mfma_f32_32x32x16_bf16 v[128:143], v[88:91], v[76:79], v[128:143]
  v_mfma_f32_32x32x16_bf16 v[144:159], v[92:95], v[76:79], v[144:159]
  s_add_u32 s51, s43, 376832
  s_add_u32 m0, s40, 14336
  s_nop 0
  buffer_load_dwordx4 v1, s[12:15], s51 offen lds
  s_add_u32 s51, s43, 385024
  s_add_u32 m0, s40, 15360
  s_nop 0
  buffer_load_dwordx4 v1, s[12:15], s51 offen lds
  s_add_u32 s50, s41, 22528
  buffer_load_dwordx4 v[64:67], v14, s[16:19], s50 offen
  s_add_u32 s50, s42, 22528
  buffer_load_dwordx4 v[68:71], v14, s[16:19], s50 offen
  s_waitcnt vmcnt(24) lgkmcnt(0)
  v_mfma_f32_32x32x16_bf16 v[96:111], v[80:83], v[16:19], v[96:111]
  v_mfma_f32_32x32x16_bf16 v[112:127], v[84:87], v[16:19], v[112:127]
  ds_read_b64_tr_b16 v[88:89], v2 offset:2048
  ds_read_b64_tr_b16 v[90:91], v2 offset:3072
  ds_read_b64_tr_b16 v[92:93], v3 offset:2048
  ds_read_b64_tr_b16 v[94:95], v3 offset:3072
  v_mfma_f32_32x32x16_bf16 v[128:143], v[80:83], v[20:23], v[128:143]
  v_mfma_f32_32x32x16_bf16 v[144:159], v[84:87], v[20:23], v[144:159]
  s_add_u32 s51, s43, 393216
  s_add_u32 m0, s40, 0
  s_nop 0
  buffer_load_dwordx4 v1, s[12:15], s51 offen lds
  s_add_u32 s51, s43, 401408
  s_add_u32 m0, s40, 1024
  s_nop 0
  buffer_load_dwordx4 v1, s[12:15], s51 offen lds
  s_add_u32 s50, s41, 23552
  buffer_load_dwordx4 v[72:75], v14, s[16:19], s50 offen
  s_add_u32 s50, s42, 23552
  buffer_load_dwordx4 v[76:79], v14, s[16:19], s50 offen
  s_waitcnt vmcnt(24) lgkmcnt(0)
  v_mfma_f32_32x32x16_bf16 v[96:111], v[88:91], v[24:27], v[96:111]
  v_mfma_f32_32x32x16_bf16 v[112:127], v[92:95], v[24:27], v[112:127]
  ds_read_b64_tr_b16 v[80:81], v2 offset:4096
  ds_read_b64_tr_b16 v[82:83], v2 offset:5120
  ds_read_b64_tr_b16 v[84:85], v3 offset:4096
  ds_read_b64_tr_b16 v[86:87], v3 offset:5120
  v_mfma_f32_32x32x16_bf16 v[128:143], v[88:91], v[28:31], v[128:143]
  v_mfma_f32_32x32x16_bf16 v[144:159], v[92:95], v[28:31], v[144:159]
  s_add_u32 s51, s43, 409600
  s_add_u32 m0, s40, 2048
  s_nop 0
  buffer_load_dwordx4 v1, s[12:15], s51 offen lds
  s_add_u32 s51, s43, 417792
  s_add_u32 m0, s40, 3072
  s_nop 0
  buffer_load_dwordx4 v1, s[12:15], s51 offen lds
  s_add_u32 s50, s41, 24576
  buffer_load_dwordx4 v[16:19], v14, s[16:19], s50 offen
  s_add_u32 s50, s42, 24576
  buffer_load_dwordx4 v[20:23], v14, s[16:19], s50 offen
  s_waitcnt vmcnt(24) lgkmcnt(0)
  v_mfma_f32_32x32x16_bf16 v[96:111], v[80:83], v[32:35], v[96:111]
  v_mfma_f32_32x32x16_bf16 v[112:127], v[84:87], v[32:35], v[112:127]
  ds_read_b64_tr_b16 v[88:89], v2 offset:6144
  ds_read_b64_tr_b16 v[90:91], v2 offset:7168
  ds_read_b64_tr_b16 v[92:93], v3 offset:6144
  ds_read_b64_tr_b16 v[94:95], v3 offset:7168
  v_mfma_f32_32x32x16_bf16 v[128:143], v[80:83], v[36:39], v[128:143]
  v_mfma_f32_32x32x16_bf16 v[144:159], v[84:87], v[36:39], v[144:159]
  s_add_u32 s51, s43, 425984
  s_add_u32 m0, s40, 4096
  s_nop 0
  buffer_load_dwordx4 v1, s[12:15], s51 offen lds
  s_add_u32 s51, s43, 434176
  s_add_u32 m0, s40, 5120
  s_nop 0
  buffer_load_dwordx4 v1, s[12:15], s51 offen lds
  s_add_u32 s50, s41, 25600
  buffer_load_dwordx4 v[24:27], v14, s[16:19], s50 offen
  s_add_u32 s50, s42, 25600
  buffer_load_dwordx4 v[28:31], v14, s[16:19], s50 offen
  s_waitcnt vmcnt(24) lgkmcnt(0)
  v_mfma_f32_32x32x16_bf16 v[96:111], v[88:91], v[40:43], v[96:111]
  v_mfma_f32_32x32x16_bf16 v[112:127], v[92:95], v[40:43], v[112:127]
  ds_read_b64_tr_b16 v[80:81], v2 offset:8192
  ds_read_b64_tr_b16 v[82:83], v2 offset:9216
  ds_read_b64_tr_b16 v[84:85], v3 offset:8192
  ds_read_b64_tr_b16 v[86:87], v3 offset:9216
  v_mfma_f32_32x32x16_bf16 v[128:143], v[88:91], v[44:47], v[128:143]
  v_mfma_f32_32x32x16_bf16 v[144:159], v[92:95], v[44:47], v[144:159]
  s_add_u32 s51, s43, 442368
  s_add_u32 m0, s40, 6144
  s_nop 0
  buffer_load_dwordx4 v1, s[12:15], s51 offen lds
  s_add_u32 s51, s43, 450560
  s_add_u32 m0, s40, 7168
  s_nop 0
  buffer_load_dwordx4 v1, s[12:15], s51 offen lds
  s_add_u32 s50, s41, 26624
  buffer_load_dwordx4 v[32:35], v14, s[16:19], s50 offen
  s_add_u32 s50, s42, 26624
  buffer_load_dwordx4 v[36:39], v14, s[16:19], s50 offen
  s_waitcnt vmcnt(24) lgkmcnt(0)
  v_mfma_f32_32x32x16_bf16 v[96:111], v[80:83], v[48:51], v[96:111]
  v_mfma_f32_32x32x16_bf16 v[112:127], v[84:87], v[48:51], v[112:127]
  ds_read_b64_tr_b16 v[88:89], v2 offset:10240
  ds_read_b64_tr_b16 v[90:91], v2 offset:11264
  ds_read_b64_tr_b16 v[92:93], v3 offset:10240
  ds_read_b64_tr_b16 v[94:95], v3 offset:11264
  v_mfma_f32_32x32x16_bf16 v[128:143], v[80:83], v[52:55], v[128:143]
  v_mfma_f32_32x32x16_bf16 v[144:159], v[84:87], v[52:55], v[144:159]
  s_add_u32 s51, s46, 0
  s_add_u32 m0, s40, 8192
  s_nop 0
  buffer_load_dwordx4 v1, s[8:11], s51 offen lds
  s_add_u32 s51, s46, 8192
  s_add_u32 m0, s40, 9216
  s_nop 0
  buffer_load_dwordx4 v1, s[8:11], s51 offen lds
  s_add_u32 s50, s41, 27648
  buffer_load_dwordx4 v[40:43], v14, s[16:19], s50 offen
  s_add_u32 s50, s42, 27648
  buffer_load_dwordx4 v[44:47], v14, s[16:19], s50 offen
  s_waitcnt vmcnt(24) lgkmcnt(0)
  v_mfma_f32_32x32x16_bf16 v[96:111], v[88:91], v[56:59], v[96:111]
  v_mfma_f32_32x32x16_bf16 v[112:127], v[92:95], v[56:59], v[112:127]
  ds_read_b64_tr_b16 v[80:81], v2 offset:12288
  ds_read_b64_tr_b16 v[82:83], v2 offset:13312
  ds_read_b64_tr_b16 v[84:85], v3 offset:12288
  ds_read_b64_tr_b16 v[86:87], v3 offset:13312
  v_mfma_f32_32x32x16_bf16 v[128:143], v[88:91], v[60:63], v[128:143]
  v_mfma_f32_32x32x16_bf16 v[144:159], v[92:95], v[60:63], v[144:159]
  s_add_u32 s51, s46, 16384
  s_add_u32 m0, s40, 10240
  s_nop 0
  buffer_load_dwordx4 v1, s[8:11], s51 offen lds
  s_add_u32 s51, s46, 24576
  s_add_u32 m0, s40, 11264
  s_nop 0
  buffer_load_dwordx4 v1, s[8:11], s51 offen lds
  v_mov_b32 v5, 1
  ds_write_b32 v4, v5 offset:12
  s_waitcnt vmcnt(22) lgkmcnt(1)
  v_mfma_f32_32x32x16_bf16 v[96:111], v[80:83], v[64:67], v[96:111]
  v_mfma_f32_32x32x16_bf16 v[112:127], v[84:87], v[64:67], v[112:127]
  ds_read_b64_tr_b16 v[88:89], v2 offset:14336
  ds_read_b64_tr_b16 v[90:91], v2 offset:15360
  ds_read_b64_tr_b16 v[92:93], v3 offset:14336
  ds_read_b64_tr_b16 v[94:95], v3 offset:15360
  v_mfma_f32_32x32x16_bf16 v[128:143], v[80:83], v[68:71], v[128:143]
  v_mfma_f32_32x32x16_bf16 v[144:159], v[84:87], v[68:71], v[144:159]
  s_add_u32 s51, s46, 32768
  s_add_u32 m0, s40, 12288
  s_nop 0
  buffer_load_dwordx4 v1, s[8:11], s51 offen lds
  s_add_u32 s51, s46, 40960
  s_add_u32 m0, s40, 13312
  s_nop 0
  buffer_load_dwordx4 v1, s[8:11], s51 offen lds
  s_waitcnt vmcnt(20) lgkmcnt(0)
  v_mfma_f32_32x32x16_bf16 v[96:111], v[88:91], v[72:75], v[96:111]
  v_mfma_f32_32x32x16_bf16 v[112:127], v[92:95], v[72:75], v[112:127]
  ds_read_b64_tr_b16 v[80:81], v2 offset:0
  ds_read_b64_tr_b16 v[82:83], v2 offset:1024
  ds_read_b64_tr_b16 v[84:85], v3 offset:0
  ds_read_b64_tr_b16 v[86:87], v3 offset:1024
  v_mfma_f32_32x32x16_bf16 v[128:143], v[88:91], v[76:79], v[128:143]
  v_mfma_f32_32x32x16_bf16 v[144:159], v[92:95], v[76:79], v[144:159]
  s_add_u32 s51, s46, 49152
  s_add_u32 m0, s40, 14336
  s_nop 0
  buffer_load_dwordx4 v1, s[8:11], s51 offen lds
  s_add_u32 s51, s46, 57344
  s_add_u32 m0, s40, 15360
  s_nop 0
  buffer_load_dwordx4 v1, s[8:11], s51 offen lds
  s_waitcnt vmcnt(18) lgkmcnt(0)
  v_mfma_f32_32x32x16_bf16 v[96:111], v[80:83], v[16:19], v[96:111]
  v_mfma_f32_32x32x16_bf16 v[112:127], v[84:87], v[16:19], v[112:127]
  ds_read_b64_tr_b16 v[88:89], v2 offset:2048
  ds_read_b64_tr_b16 v[90:91], v2 offset:3072
  ds_read_b64_tr_b16 v[92:93], v3 offset:2048
  ds_read_b64_tr_b16 v[94:95], v3 offset:3072
  v_mfma_f32_32x32x16_bf16 v[128:143], v[80:83], v[20:23], v[128:143]
  v_mfma_f32_32x32x16_bf16 v[144:159], v[84:87], v[20:23], v[144:159]
  s_add_u32 s51, s46, 65536
  s_add_u32 m0, s40, 0
  s_nop 0
  buffer_load_dwordx4 v1, s[8:11], s51 offen lds
  s_add_u32 s51, s46, 73728
  s_add_u32 m0, s40, 1024
  s_nop 0
  buffer_load_dwordx4 v1, s[8:11], s51 offen lds
  s_waitcnt vmcnt(16) lgkmcnt(0)
  v_mfma_f32_32x32x16_bf16 v[96:111], v[88:91], v[24:27], v[96:111]
  v_mfma_f32_32x32x16_bf16 v[112:127], v[92:95], v[24:27], v[112:127]
  ds_read_b64_tr_b16 v[80:81], v2 offset:4096
  ds_read_b64_tr_b16 v[82:83], v2 offset:5120
  ds_read_b64_tr_b16 v[84:85], v3 offset:4096
  ds_read_b64_tr_b16 v[86:87], v3 offset:5120
  v_mfma_f32_32x32x16_bf16 v[128:143], v[88:91], v[28:31], v[128:143]
  v_mfma_f32_32x32x16_bf16 v[144:159], v[92:95], v[28:31], v[144:159]
  s_add_u32 s51, s46, 81920
  s_add_u32 m0, s40, 2048
  s_nop 0
  buffer_load_dwordx4 v1, s[8:11], s51 offen lds
  s_add_u32 s51, s46, 90112
  s_add_u32 m0, s40, 3072
  s_nop 0
  buffer_load_dwordx4 v1, s[8:11], s51 offen lds
  s_waitcnt vmcnt(14) lgkmcnt(0)
  v_mfma_f32_32x32x16_bf16 v[96:111], v[80:83], v[32:35], v[96:111]
  v_mfma_f32_32x32x16_bf16 v[112:127], v[84:87], v[32:35], v[112:127]
  ds_read_b64_tr_b16 v[88:89], v2 offset:6144
  ds_read_b64_tr_b16 v[90:91], v2 offset:7168
  ds_read_b64_tr_b16 v[92:93], v3 offset:6144
  ds_read_b64_tr_b16 v[94:95], v3 offset:7168
  v_mfma_f32_32x32x16_bf16 v[128:143], v[80:83], v[36:39], v[128:143]
  v_mfma_f32_32x32x16_bf16 v[144:159], v[84:87], v[36:39], v[144:159]
  s_add_u32 s51, s46, 98304
  s_add_u32 m0, s40, 4096
  s_nop 0
  buffer_load_dwordx4 v1, s[8:11], s51 offen lds
  s_add_u32 s51, s46, 106496
  s_add_u32 m0, s40, 5120
  s_nop 0
  buffer_load_dwordx4 v1, s[8:11], s51 offen lds
  s_waitcnt vmcnt(12) lgkmcnt(0)
  v_mfma_f32_32x32x16_bf16 v[96:111], v[88:91], v[40:43], v[96:111]
  v_mfma_f32_32x32x16_bf16 v[112:127], v[92:95], v[40:43], v[112:127]
  ds_read_b64_tr_b16 v[80:81], v2 offset:8192
  ds_read_b64_tr_b16 v[82:83], v2 offset:9216
  ds_read_b64_tr_b16 v[84:85], v3 offset:8192
  ds_read_b64_tr_b16 v[86:87], v3 offset:9216
  v_mfma_f32_32x32x16_bf16 v[128:143], v[88:91], v[44:47], v[128:143]
  v_mfma_f32_32x32x16_bf16 v[144:159], v[92:95], v[44:47], v[144:159]
  s_add_u32 s51, s46, 114688
  s_add_u32 m0, s40, 6144
  s_nop 0
  buffer_load_dwordx4 v1, s[8:11], s51 offen lds
  s_add_u32 s51, s46, 122880
  s_add_u32 m0, s40, 7168
  s_nop 0
  buffer_load_dwordx4 v1, s[8:11], s51 offen lds
K2_FW:
  ds_read_b32 v5, v4
  s_waitcnt lgkmcnt(0)
  v_readfirstlane_b32 s52, v5
  s_nop 0
  s_cmp_lg_u32 s52, 0
  s_cbranch_scc1 K2_FOK
  s_sleep 1
  s_branch K2_FW
K2_FOK:
  s_add_u32 s50, s44, 0
  buffer_load_dwordx4 v[48:51], v14, s[16:19], s50 offen sc1
  s_add_u32 s50, s45, 0
  buffer_load_dwordx4 v[52:55], v14, s[16:19], s50 offen sc1
  s_add_u32 s50, s44, 1024
  buffer_load_dwordx4 v[56:59], v14, s[16:19], s50 offen sc1
  s_add_u32 s50, s45, 1024
  buffer_load_dwordx4 v[60:63], v14, s[16:19], s50 offen sc1
  s_add_u32 s50, s44, 2048
  buffer_load_dwordx4 v[64:67], v14, s[16:19], s50 offen sc1
  s_add_u32 s50, s45, 2048
  buffer_load_dwordx4 v[68:71], v14, s[16:19], s50 offen sc1
  s_add_u32 s50, s44, 3072
  buffer_load_dwordx4 v[72:75], v14, s[16:19], s50 offen sc1
  s_add_u32 s50, s45, 3072
  buffer_load_dwordx4 v[76:79], v14, s[16:19], s50 offen sc1
  s_add_u32 s50, s44, 4096
  buffer_load_dwordx4 v[16:19], v14, s[16:19], s50 offen sc1
  s_add_u32 s50, s45, 4096
  buffer_load_dwordx4 v[20:23], v14, s[16:19], s50 offen sc1
  s_add_u32 s50, s44, 5120
  buffer_load_dwordx4 v[24:27], v14, s[16:19], s50 offen sc1
  s_add_u32 s50, s45, 5120
  buffer_load_dwordx4 v[28:31], v14, s[16:19], s50 offen sc1
  s_add_u32 s50, s44, 6144
  buffer_load_dwordx4 v[32:35], v14, s[16:19], s50 offen sc1
  s_add_u32 s50, s45, 6144
  buffer_load_dwordx4 v[36:39], v14, s[16:19], s50 offen sc1
  s_waitcnt vmcnt(12)
  v_mfma_f32_32x32x16_bf16 v[96:111], v[80:83], v[48:51], v[96:111]
  v_mfma_f32_32x32x16_bf16 v[112:127], v[84:87], v[48:51], v[112:127]
  ds_read_b64_tr_b16 v[88:89], v2 offset:10240
  ds_read_b64_tr_b16 v[90:91], v2 offset:11264
  ds_read_b64_tr_b16 v[92:93], v3 offset:10240
  ds_read_b64_tr_b16 v[94:95], v3 offset:11264
  v_mfma_f32_32x32x16_bf16 v[128:143], v[80:83], v[52:55], v[128:143]
  v_mfma_f32_32x32x16_bf16 v[144:159], v[84:87], v[52:55], v[144:159]
  s_add_u32 s50, s44, 7168
  buffer_load_dwordx4 v[40:43], v14, s[16:19], s50 offen sc1
  s_add_u32 s50, s45, 7168
  buffer_load_dwordx4 v[44:47], v14, s[16:19], s50 offen sc1
  s_waitcnt vmcnt(12) lgkmcnt(0)
  v_mfma_f32_32x32x16_bf16 v[96:111], v[88:91], v[56:59], v[96:111]
  v_mfma_f32_32x32x16_bf16 v[112:127], v[92:95], v[56:59], v[112:127]
  ds_read_b64_tr_b16 v[80:81], v2 offset:12288
  ds_read_b64_tr_b16 v[82:83], v2 offset:13312
  ds_read_b64_tr_b16 v[84:85], v3 offset:12288
  ds_read_b64_tr_b16 v[86:87], v3 offset:13312
  v_mfma_f32_32x32x16_bf16 v[128:143], v[88:91], v[60:63], v[128:143]
  v_mfma_f32_32x32x16_bf16 v[144:159], v[92:95], v[60:63], v[144:159]
  s_waitcnt vmcnt(10) lgkmcnt(0)
  v_mfma_f32_32x32x16_bf16 v[96:111], v[80:83], v[64:67], v[96:111]
  v_mfma_f32_32x32x16_bf16 v[112:127], v[84:87], v[64:67], v[112:127]
  ds_read_b64_tr_b16 v[88:89], v2 offset:14336
  ds_read_b64_tr_b16 v[90:91], v2 offset:15360
  ds_read_b64_tr_b16 v[92:93], v3 offset:14336
  ds_read_b64_tr_b16 v[94:95], v3 offset:15360
  v_mfma_f32_32x32x16_bf16 v[128:143], v[80:83], v[68:71], v[128:143]
  v_mfma_f32_32x32x16_bf16 v[144:159], v[84:87], v[68:71], v[144:159]
  s_waitcnt vmcnt(8) lgkmcnt(0)
  v_mfma_f32_32x32x16_bf16 v[96:111], v[88:91], v[72:75], v[96:111]
  v_mfma_f32_32x32x16_bf16 v[112:127], v[92:95], v[72:75], v[112:127]
  ds_read_b64_tr_b16 v[80:81], v2 offset:0
  ds_read_b64_tr_b16 v[82:83], v2 offset:1024
  ds_read_b64_tr_b16 v[84:85], v3 offset:0
  ds_read_b64_tr_b16 v[86:87], v3 offset:1024
  v_mfma_f32_32x32x16_bf16 v[128:143], v[88:91], v[76:79], v[128:143]
  v_mfma_f32_32x32x16_bf16 v[144:159], v[92:95], v[76:79], v[144:159]
  s_waitcnt vmcnt(6) lgkmcnt(0)
  v_mfma_f32_32x32x16_bf16 v[96:111], v[80:83], v[16:19], v[96:111]
  v_mfma_f32_32x32x16_bf16 v[112:127], v[84:87], v[16:19], v[112:127]
  ds_read_b64_tr_b16 v[88:89], v2 offset:2048
  ds_read_b64_tr_b16 v[90:91], v2 offset:3072
  ds_read_b64_tr_b16 v[92:93], v3 offset:2048
  ds_read_b64_tr_b16 v[94:95], v3 offset:3072
  v_mfma_f32_32x32x16_bf16 v[128:143], v[80:83], v[20:23], v[128:143]
  v_mfma_f32_32x32x16_bf16 v[144:159], v[84:87], v[20:23], v[144:159]
  s_waitcnt vmcnt(4) lgkmcnt(0)
  v_mfma_f32_32x32x16_bf16 v[96:111], v[88:91], v[24:27], v[96:111]
  v_mfma_f32_32x32x16_bf16 v[112:127], v[92:95], v[24:27], v[112:127]
  ds_read_b64_tr_b16 v[80:81], v2 offset:4096
  ds_read_b64_tr_b16 v[82:83], v2 offset:5120
  ds_read_b64_tr_b16 v[84:85], v3 offset:4096
  ds_read_b64_tr_b16 v[86:87], v3 offset:5120
  v_mfma_f32_32x32x16_bf16 v[128:143], v[88:91], v[28:31], v[128:143]
  v_mfma_f32_32x32x16_bf16 v[144:159], v[92:95], v[28:31], v[144:159]
  s_waitcnt vmcnt(2) lgkmcnt(0)
  v_mfma_f32_32x32x16_bf16 v[96:111], v[80:83], v[32:35], v[96:111]
  v_mfma_f32_32x32x16_bf16 v[112:127], v[84:87], v[32:35], v[112:127]
  ds_read_b64_tr_b16 v[88:89], v2 offset:6144
  ds_read_b64_tr_b16 v[90:91], v2 offset:7168
  ds_read_b64_tr_b16 v[92:93], v3 offset:6144
  ds_read_b64_tr_b16 v[94:95], v3 offset:7168
  v_mfma_f32_32x32x16_bf16 v[128:143], v[80:83], v[36:39], v[128:143]
  v_mfma_f32_32x32x16_bf16 v[144:159], v[84:87], v[36:39], v[144:159]
  s_waitcnt vmcnt(0) lgkmcnt(0)
  v_mfma_f32_32x32x16_bf16 v[96:111], v[88:91], v[40:43], v[96:111]
  v_mfma_f32_32x32x16_bf16 v[112:127], v[92:95], v[40:43], v[112:127]
  v_mfma_f32_32x32x16_bf16 v[128:143], v[88:91], v[44:47], v[128:143]
  v_mfma_f32_32x32x16_bf16 v[144:159], v[92:95], v[44:47], v[144:159]
  v_and_b32 v5, 31, v0
  v_mul_u32_u24 v5, 272, v5
  v_lshrrev_b32 v6, 5, v0
  v_lshl_add_u32 v5, v6, 4, v5
  v_add_u32 v5, s40, v5
  s_nop 3
  ds_write_b128 v5, v[96:99] offset:0
  ds_write_b128 v5, v[100:103] offset:32
  ds_write_b128 v5, v[104:107] offset:64
  ds_write_b128 v5, v[108:111] offset:96
  ds_write_b128 v5, v[112:115] offset:128
  ds_write_b128 v5, v[116:119] offset:160
  ds_write_b128 v5, v[120:123] offset:192
  ds_write_b128 v5, v[124:127] offset:224
  ds_write_b128 v5, v[128:131] offset:8704
  ds_write_b128 v5, v[132:135] offset:8736
  ds_write_b128 v5, v[136:139] offset:8768
  ds_write_b128 v5, v[140:143] offset:8800
  ds_write_b128 v5, v[144:147] offset:8832
  ds_write_b128 v5, v[148:151] offset:8864
  ds_write_b128 v5, v[152:155] offset:8896
  ds_write_b128 v5, v[156:159] offset:8928
  s_waitcnt lgkmcnt(0)
  v_add_u32 v11, 34816, v12
  s_barrier
  ds_read_b128 v[192:195], v12 offset:0
  ds_read_b128 v[196:199], v12 offset:16
  ds_read_b128 v[200:203], v12 offset:17408
  ds_read_b128 v[204:207], v12 offset:17424
  ds_read_b128 v[208:211], v11 offset:0
  ds_read_b128 v[212:215], v11 offset:16
  ds_read_b128 v[216:219], v11 offset:17408
  ds_read_b128 v[220:223], v11 offset:17424
  v_lshlrev_b32 v64, 16, v232
  v_and_b32 v65, 0xffff0000, v232
  v_lshlrev_b32 v66, 16, v233
  v_and_b32 v67, 0xffff0000, v233
  v_lshlrev_b32 v68, 16, v234
  v_and_b32 v69, 0xffff0000, v234
  v_lshlrev_b32 v70, 16, v235
  v_and_b32 v71, 0xffff0000, v235
  s_waitcnt lgkmcnt(0)
  v_add_f32 v192, v192, v200
  v_add_f32 v193, v193, v201
  v_add_f32 v194, v194, v202
  v_add_f32 v195, v195, v203
  v_add_f32 v196, v196, v204
  v_add_f32 v197, v197, v205
  v_add_f32 v198, v198, v206
  v_add_f32 v199, v199, v207
  v_add_f32 v208, v208, v216
  v_add_f32 v209, v209, v217
  v_add_f32 v210, v210, v218
  v_add_f32 v211, v211, v219
  v_add_f32 v212, v212, v220
  v_add_f32 v213, v213, v221
  v_add_f32 v214, v214, v222
  v_add_f32 v215, v215, v223
  v_add_f32 v192, v192, v208
  v_add_f32 v193, v193, v209
  v_add_f32 v194, v194, v210
  v_add_f32 v195, v195, v211
  v_add_f32 v196, v196, v212
  v_add_f32 v197, v197, v213
  v_add_f32 v198, v198, v214
  v_add_f32 v199, v199, v215
  v_add_f32 v192, v192, v64
  v_add_f32 v193, v193, v65
  v_add_f32 v194, v194, v66
  v_add_f32 v195, v195, v67
  v_add_f32 v196, v196, v68
  v_add_f32 v197, v197, v69
  v_add_f32 v198, v198, v70
  v_add_f32 v199, v199, v71
  v_cvt_pk_bf16_f32 v72, v192, v193
  v_cvt_pk_bf16_f32 v73, v194, v195
  v_cvt_pk_bf16_f32 v74, v196, v197
  v_cvt_pk_bf16_f32 v75, v198, v199
  buffer_store_dwordx4 v[72:75], v13, s[28:31], s23 offen sc1
  s_endpgm
K2_ATT:
  s_setprio 3
  s_sub_u32 s36, s20, 4
  s_lshl_b32 s40, s22, 2
  s_add_u32 s40, s40, s36
  s_lshl_b32 s41, s21, 1
  s_sub_u32 s41, s41, 8
  s_lshl_b32 s42, s40, 16
  v_and_b32 v1, 15, v0
  v_lshrrev_b32 v2, 5, v0
  v_lshlrev_b32 v1, 4, v1
  v_lshl_add_u32 v1, v2, 8, v1
  v_bfe_u32 v3, v0, 4, 1
  v_lshl_add_u32 v1, v3, 9, v1
  v_and_b32 v3, 31, v0
  v_lshlrev_b32 v2, 2, v2
  v_sub_u32 v3, v3, v2
  v_mov_b32 v4, 0xf149f2ca
  s_lshl_b32 s37, s21, 11
  s_add_u32 s37, s37, s42
  buffer_load_dwordx4 v[16:19], v14, s[16:19], s37 offen
  s_add_i32 s36, s41, 8
  s_max_i32 s36, s36, 0
  s_lshl_b32 s36, s36, 10
  s_add_u32 s52, s36, s42
  s_add_u32 s36, s52, 2097152
  buffer_load_dwordx4 v[56:59], v14, s[16:19], s36 offen
  s_add_i32 s36, s41, 7
  s_max_i32 s36, s36, 0
  s_lshl_b32 s36, s36, 10
  s_add_u32 s51, s36, s42
  s_add_u32 s36, s51, 2097152
  buffer_load_dwordx4 v[52:55], v14, s[16:19], s36 offen
  s_add_i32 s36, s41, 6
  s_max_i32 s36, s36, 0
  s_lshl_b32 s36, s36, 10
  s_add_u32 s50, s36, s42
  s_add_u32 s36, s50, 2097152
  buffer_load_dwordx4 v[48:51], v14, s[16:19], s36 offen
  s_add_i32 s36, s41, 5
  s_max_i32 s36, s36, 0
  s_lshl_b32 s36, s36, 10
  s_add_u32 s49, s36, s42
  s_add_u32 s36, s49, 2097152
  buffer_load_dwordx4 v[44:47], v14, s[16:19], s36 offen
  s_add_i32 s36, s41, 4
  s_max_i32 s36, s36, 0
  s_lshl_b32 s36, s36, 10
  s_add_u32 s48, s36, s42
  s_add_u32 s36, s48, 2097152
  buffer_load_dwordx4 v[40:43], v14, s[16:19], s36 offen
  s_add_i32 s36, s41, 3
  s_max_i32 s36, s36, 0
  s_lshl_b32 s36, s36, 10
  s_add_u32 s47, s36, s42
  s_add_u32 s36, s47, 2097152
  buffer_load_dwordx4 v[36:39], v14, s[16:19], s36 offen
  s_add_i32 s36, s41, 2
  s_max_i32 s36, s36, 0
  s_lshl_b32 s36, s36, 10
  s_add_u32 s46, s36, s42
  s_add_u32 s36, s46, 2097152
  buffer_load_dwordx4 v[32:35], v14, s[16:19], s36 offen
  s_add_i32 s36, s41, 1
  s_max_i32 s36, s36, 0
  s_lshl_b32 s36, s36, 10
  s_add_u32 s45, s36, s42
  s_add_u32 s36, s45, 2097152
  buffer_load_dwordx4 v[28:31], v14, s[16:19], s36 offen
  s_add_i32 s36, s41, 0
  s_max_i32 s36, s36, 0
  s_lshl_b32 s36, s36, 10
  s_add_u32 s44, s36, s42
  s_add_u32 s36, s44, 2097152
  buffer_load_dwordx4 v[24:27], v14, s[16:19], s36 offen
  buffer_load_dwordx4 v[20:23], v14, s[16:19], s37 offen offset:1024
  s_add_i32 s36, s41, 9
  s_max_i32 s36, s36, 0
  s_lshl_b32 s36, s36, 10
  s_add_u32 s53, s36, s42
  s_add_u32 s36, s53, 2097152
  buffer_load_dwordx4 v[60:63], v14, s[16:19], s36 offen
  v_cmp_ge_i32 s[64:65], v3, 0
  v_cmp_ge_i32 s[66:67], v3, 1
  v_cmp_ge_i32 s[68:69], v3, 2
  v_cmp_ge_i32 s[70:71], v3, 3
  v_cmp_ge_i32 s[72:73], v3, 8
  v_cmp_ge_i32 s[74:75], v3, 9
  v_cmp_ge_i32 s[76:77], v3, 10
  v_cmp_ge_i32 s[78:79], v3, 11
  v_cmp_ge_i32 s[80:81], v3, 16
  v_cmp_ge_i32 s[82:83], v3, 17
  v_cmp_ge_i32 s[84:85], v3, 18
  v_cmp_ge_i32 s[86:87], v3, 19
  v_cmp_ge_i32 s[88:89], v3, 24
  v_cmp_ge_i32 s[90:91], v3, 25
  v_cmp_ge_i32 s[92:93], v3, 26
  v_cmp_ge_i32 s[94:95], v3, 27
  v_mov_b32 v68, 0x3f803f80
  v_mov_b32 v69, 0x3f803f80
  v_mov_b32 v70, 0x3f803f80
  v_mov_b32 v71, 0x3f803f80
  v_mov_b32 v76, 0x3f803f80
  v_mov_b32 v77, 0x3f803f80
  v_mov_b32 v78, 0x3f803f80
  v_mov_b32 v79, 0x3f803f80
  v_mov_b32 v84, 0x3f803f80
  v_mov_b32 v85, 0x3f803f80
  v_mov_b32 v86, 0x3f803f80
  v_mov_b32 v87, 0x3f803f80
  v_mov_b32 v92, 0x3f803f80
  v_mov_b32 v93, 0x3f803f80
  v_mov_b32 v94, 0x3f803f80
  v_mov_b32 v95, 0x3f803f80
  v_mov_b32 v100, 0x3f803f80
  v_mov_b32 v101, 0x3f803f80
  v_mov_b32 v102, 0x3f803f80
  v_mov_b32 v103, 0x3f803f80
  v_mov_b32 v108, 0x3f803f80
  v_mov_b32 v109, 0x3f803f80
  v_mov_b32 v110, 0x3f803f80
  v_mov_b32 v111, 0x3f803f80
  v_mov_b32 v116, 0x3f803f80
  v_mov_b32 v117, 0x3f803f80
  v_mov_b32 v118, 0x3f803f80
  v_mov_b32 v119, 0x3f803f80
  v_mov_b32 v124, 0x3f803f80
  v_mov_b32 v125, 0x3f803f80
  v_mov_b32 v126, 0x3f803f80
  v_mov_b32 v127, 0x3f803f80
  v_mov_b32 v132, 0x3f803f80
  v_mov_b32 v133, 0x3f803f80
  v_mov_b32 v134, 0x3f803f80
  v_mov_b32 v135, 0x3f803f80
  v_mov_b32 v140, 0x3f803f80
  v_mov_b32 v141, 0x3f803f80
  v_mov_b32 v142, 0x3f803f80
  v_mov_b32 v143, 0x3f803f80
  s_cmp_ge_u32 s21, 4
  s_cbranch_scc1 K2_AFAST
  s_add_u32 s36, s52, 4194304
  buffer_load_dwordx4 v[128:131], v1, s[16:19], s36 offen
  s_add_u32 s36, s51, 4194304
  buffer_load_dwordx4 v[120:123], v1, s[16:19], s36 offen
  s_add_u32 s36, s50, 4194304
  buffer_load_dwordx4 v[112:115], v1, s[16:19], s36 offen
  s_add_u32 s36, s49, 4194304
  buffer_load_dwordx4 v[104:107], v1, s[16:19], s36 offen
  s_add_u32 s36, s48, 4194304
  buffer_load_dwordx4 v[96:99], v1, s[16:19], s36 offen
  s_add_u32 s36, s47, 4194304
  buffer_load_dwordx4 v[88:91], v1, s[16:19], s36 offen
  s_add_u32 s36, s46, 4194304
  buffer_load_dwordx4 v[80:83], v1, s[16:19], s36 offen
  s_add_u32 s36, s45, 4194304
  buffer_load_dwordx4 v[72:75], v1, s[16:19], s36 offen
  s_add_u32 s36, s44, 4194304
  buffer_load_dwordx4 v[64:67], v1, s[16:19], s36 offen
  s_add_u32 s36, s53, 4194304
  buffer_load_dwordx4 v[136:139], v1, s[16:19], s36 offen
  buffer_load_dwordx4 v[232:235], v13, s[4:7], s23 offen
  s_waitcnt vmcnt(0)
  v_permlane16_swap_b32 v64, v68
  v_permlane16_swap_b32 v65, v69
  v_permlane16_swap_b32 v66, v70
  v_permlane16_swap_b32 v67, v71
  v_permlane16_swap_b32 v72, v76
  v_permlane16_swap_b32 v73, v77
  v_permlane16_swap_b32 v74, v78
  v_permlane16_swap_b32 v75, v79
  v_permlane16_swap_b32 v80, v84
  v_permlane16_swap_b32 v81, v85
  v_permlane16_swap_b32 v82, v86
  v_permlane16_swap_b32 v83, v87
  v_permlane16_swap_b32 v88, v92
  v_permlane16_swap_b32 v89, v93
  v_permlane16_swap_b32 v90, v94
  v_permlane16_swap_b32 v91, v95
  v_permlane16_swap_b32 v96, v100
  v_permlane16_swap_b32 v97, v101
  v_permlane16_swap_b32 v98, v102
  v_permlane16_swap_b32 v99, v103
  v_permlane16_swap_b32 v104, v108
  v_permlane16_swap_b32 v105, v109
  v_permlane16_swap_b32 v106, v110
  v_permlane16_swap_b32 v107, v111
  v_permlane16_swap_b32 v112, v116
  v_permlane16_swap_b32 v113, v117
  v_permlane16_swap_b32 v114, v118
  v_permlane16_swap_b32 v115, v119
  v_permlane16_swap_b32 v120, v124
  v_permlane16_swap_b32 v121, v125
  v_permlane16_swap_b32 v122, v126
  v_permlane16_swap_b32 v123, v127
  v_permlane16_swap_b32 v128, v132
  v_permlane16_swap_b32 v129, v133
  v_permlane16_swap_b32 v130, v134
  v_permlane16_swap_b32 v131, v135
  v_permlane16_swap_b32 v136, v140
  v_permlane16_swap_b32 v137, v141
  v_permlane16_swap_b32 v138, v142
  v_permlane16_swap_b32 v139, v143
  v_mov_b32 v5, v4
  v_cndmask_b32 v192, v4, 0, s[64:65]
  v_cndmask_b32 v193, v4, 0, s[66:67]
  v_cndmask_b32 v194, v4, 0, s[68:69]
  v_cndmask_b32 v195, v4, 0, s[70:71]
  v_cndmask_b32 v196, v4, 0, s[72:73]
  v_cndmask_b32 v197, v4, 0, s[74:75]
  v_cndmask_b32 v198, v4, 0, s[76:77]
  v_cndmask_b32 v199, v4, 0, s[78:79]
  v_cndmask_b32 v200, v4, 0, s[80:81]
  v_cndmask_b32 v201, v4, 0, s[82:83]
  v_cndmask_b32 v202, v4, 0, s[84:85]
  v_cndmask_b32 v203, v4, 0, s[86:87]
  v_cndmask_b32 v204, v4, 0, s[88:89]
  v_cndmask_b32 v205, v4, 0, s[90:91]
  v_cndmask_b32 v206, v4, 0, s[92:93]
  v_cndmask_b32 v207, v4, 0, s[94:95]
  s_nop 1
  v_mfma_f32_32x32x16_bf16 v[144:159], v[56:59], v[16:19], v[192:207]
  s_add_i32 s36, s41, 7
  s_cmp_lt_i32 s36, 0
  s_cbranch_scc1 K2_S2
  v_mfma_f32_32x32x16_bf16 v[160:175], v[52:55], v[16:19], 0
K2_S2:
  s_nop 8
  v_max3_f32 v5, v144, v145, v5
  v_max3_f32 v5, v146, v147, v5
  v_max3_f32 v5, v148, v149, v5
  v_max3_f32 v5, v150, v151, v5
  v_max3_f32 v5, v152, v153, v5
  v_max3_f32 v5, v154, v155, v5
  v_max3_f32 v5, v156, v157, v5
  v_max3_f32 v5, v158, v159, v5
  s_add_i32 s36, s41, 7
  s_cmp_lt_i32 s36, 0
  s_cbranch_scc1 K2_D1
  s_add_i32 s36, s41, 6
  s_cmp_lt_i32 s36, 0
  s_cbranch_scc1 K2_S3
  v_mfma_f32_32x32x16_bf16 v[144:159], v[48:51], v[16:19], 0
K2_S3:
  v_max3_f32 v5, v160, v161, v5
  v_max3_f32 v5, v162, v163, v5
  v_max3_f32 v5, v164, v165, v5
  v_max3_f32 v5, v166, v167, v5
  v_max3_f32 v5, v168, v169, v5
  v_max3_f32 v5, v170, v171, v5
  v_max3_f32 v5, v172, v173, v5
  v_max3_f32 v5, v174, v175, v5
  s_add_i32 s36, s41, 6
  s_cmp_lt_i32 s36, 0
  s_cbranch_scc1 K2_D1
  s_add_i32 s36, s41, 5
  s_cmp_lt_i32 s36, 0
  s_cbranch_scc1 K2_S4
  v_mfma_f32_32x32x16_bf16 v[160:175], v[44:47], v[16:19], 0
K2_S4:
  v_max3_f32 v5, v144, v145, v5
  v_max3_f32 v5, v146, v147, v5
  v_max3_f32 v5, v148, v149, v5
  v_max3_f32 v5, v150, v151, v5
  v_max3_f32 v5, v152, v153, v5
  v_max3_f32 v5, v154, v155, v5
  v_max3_f32 v5, v156, v157, v5
  v_max3_f32 v5, v158, v159, v5
  s_add_i32 s36, s41, 5
  s_cmp_lt_i32 s36, 0
  s_cbranch_scc1 K2_D1
  s_add_i32 s36, s41, 4
  s_cmp_lt_i32 s36, 0
  s_cbranch_scc1 K2_S5
  v_mfma_f32_32x32x16_bf16 v[144:159], v[40:43], v[16:19], 0
K2_S5:
  v_max3_f32 v5, v160, v161, v5
  v_max3_f32 v5, v162, v163, v5
  v_max3_f32 v5, v164, v165, v5
  v_max3_f32 v5, v166, v167, v5
  v_max3_f32 v5, v168, v169, v5
  v_max3_f32 v5, v170, v171, v5
  v_max3_f32 v5, v172, v173, v5
  v_max3_f32 v5, v174, v175, v5
  s_add_i32 s36, s41, 4
  s_cmp_lt_i32 s36, 0
  s_cbranch_scc1 K2_D1
  s_add_i32 s36, s41, 3
  s_cmp_lt_i32 s36, 0
  s_cbranch_scc1 K2_S6
  v_mfma_f32_32x32x16_bf16 v[160:175], v[36:39], v[16:19], 0
K2_S6:
  v_max3_f32 v5, v144, v145, v5
  v_max3_f32 v5, v146, v147, v5
  v_max3_f32 v5, v148, v149, v5
  v_max3_f32 v5, v150, v151, v5
  v_max3_f32 v5, v152, v153, v5
  v_max3_f32 v5, v154, v155, v5
  v_max3_f32 v5, v156, v157, v5
  v_max3_f32 v5, v158, v159, v5
  s_add_i32 s36, s41, 3
  s_cmp_lt_i32 s36, 0
  s_cbranch_scc1 K2_D1
  s_add_i32 s36, s41, 2
  s_cmp_lt_i32 s36, 0
  s_cbranch_scc1 K2_S7
  v_mfma_f32_32x32x16_bf16 v[144:159], v[32:35], v[16:19], 0
K2_S7:
  v_max3_f32 v5, v160, v161, v5
  v_max3_f32 v5, v162, v163, v5
  v_max3_f32 v5, v164, v165, v5
  v_max3_f32 v5, v166, v167, v5
  v_max3_f32 v5, v168, v169, v5
  v_max3_f32 v5, v170, v171, v5
  v_max3_f32 v5, v172, v173, v5
  v_max3_f32 v5, v174, v175, v5
  s_add_i32 s36, s41, 2
  s_cmp_lt_i32 s36, 0
  s_cbranch_scc1 K2_D1
  s_add_i32 s36, s41, 1
  s_cmp_lt_i32 s36, 0
  s_cbranch_scc1 K2_S8
  v_mfma_f32_32x32x16_bf16 v[160:175], v[28:31], v[16:19], 0
K2_S8:
  v_max3_f32 v5, v144, v145, v5
  v_max3_f32 v5, v146, v147, v5
  v_max3_f32 v5, v148, v149, v5
  v_max3_f32 v5, v150, v151, v5
  v_max3_f32 v5, v152, v153, v5
  v_max3_f32 v5, v154, v155, v5
  v_max3_f32 v5, v156, v157, v5
  v_max3_f32 v5, v158, v159, v5
  s_add_i32 s36, s41, 1
  s_cmp_lt_i32 s36, 0
  s_cbranch_scc1 K2_D1
  s_add_i32 s36, s41, 0
  s_cmp_lt_i32 s36, 0
  s_cbranch_scc1 K2_S9
  v_cndmask_b32 v192, 0, v4, s[64:65]
  v_cndmask_b32 v193, 0, v4, s[66:67]
  v_cndmask_b32 v194, 0, v4, s[68:69]
  v_cndmask_b32 v195, 0, v4, s[70:71]
  v_cndmask_b32 v196, 0, v4, s[72:73]
  v_cndmask_b32 v197, 0, v4, s[74:75]
  v_cndmask_b32 v198, 0, v4, s[76:77]
  v_cndmask_b32 v199, 0, v4, s[78:79]
  v_cndmask_b32 v200, 0, v4, s[80:81]
  v_cndmask_b32 v201, 0, v4, s[82:83]
  v_cndmask_b32 v202, 0, v4, s[84:85]
  v_cndmask_b32 v203, 0, v4, s[86:87]
  v_cndmask_b32 v204, 0, v4, s[88:89]
  v_cndmask_b32 v205, 0, v4, s[90:91]
  v_cndmask_b32 v206, 0, v4, s[92:93]
  v_cndmask_b32 v207, 0, v4, s[94:95]
  s_nop 1
  v_mfma_f32_32x32x16_bf16 v[144:159], v[24:27], v[16:19], v[192:207]
K2_S9:
  v_max3_f32 v5, v160, v161, v5
  v_max3_f32 v5, v162, v163, v5
  v_max3_f32 v5, v164, v165, v5
  v_max3_f32 v5, v166, v167, v5
  v_max3_f32 v5, v168, v169, v5
  v_max3_f32 v5, v170, v171, v5
  v_max3_f32 v5, v172, v173, v5
  v_max3_f32 v5, v174, v175, v5
  s_add_i32 s36, s41, 0
  s_cmp_lt_i32 s36, 0
  s_cbranch_scc1 K2_D1
  s_nop 0
  v_max3_f32 v5, v144, v145, v5
  v_max3_f32 v5, v146, v147, v5
  v_max3_f32 v5, v148, v149, v5
  v_max3_f32 v5, v150, v151, v5
  v_max3_f32 v5, v152, v153, v5
  v_max3_f32 v5, v154, v155, v5
  v_max3_f32 v5, v156, v157, v5
  v_max3_f32 v5, v158, v159, v5
K2_D1:
  s_nop 15
  v_mov_b32 v6, v5
  s_nop 1
  v_permlane32_swap_b32 v5, v6
  v_max_f32 v5, v5, v6
  v_sub_f32 v176, 0, v5
  v_mov_b32 v177, v176
  v_mov_b32 v178, v176
  v_mov_b32 v179, v176
  v_mov_b32 v180, v176
  v_mov_b32 v181, v176
  v_mov_b32 v182, v176
  v_mov_b32 v183, v176
  v_mov_b32 v184, v176
  v_mov_b32 v185, v176
  v_mov_b32 v186, v176
  v_mov_b32 v187, v176
  v_mov_b32 v188, v176
  v_mov_b32 v189, v176
  v_mov_b32 v190, v176
  v_mov_b32 v191, v176
  v_cndmask_b32 v192, v4, v176, s[64:65]
  v_cndmask_b32 v193, v4, v176, s[66:67]
  v_cndmask_b32 v194, v4, v176, s[68:69]
  v_cndmask_b32 v195, v4, v176, s[70:71]
  v_cndmask_b32 v196, v4, v176, s[72:73]
  v_cndmask_b32 v197, v4, v176, s[74:75]
  v_cndmask_b32 v198, v4, v176, s[76:77]
  v_cndmask_b32 v199, v4, v176, s[78:79]
  v_cndmask_b32 v200, v4, v176, s[80:81]
  v_cndmask_b32 v201, v4, v176, s[82:83]
  v_cndmask_b32 v202, v4, v176, s[84:85]
  v_cndmask_b32 v203, v4, v176, s[86:87]
  v_cndmask_b32 v204, v4, v176, s[88:89]
  v_cndmask_b32 v205, v4, v176, s[90:91]
  v_cndmask_b32 v206, v4, v176, s[92:93]
  v_cndmask_b32 v207, v4, v176, s[94:95]
  s_nop 1
  v_mfma_f32_32x32x16_bf16 v[144:159], v[56:59], v[16:19], v[192:207]
  s_add_i32 s36, s41, 7
  s_cmp_lt_i32 s36, 0
  s_cbranch_scc1 K2_S11
  v_mfma_f32_32x32x16_bf16 v[160:175], v[52:55], v[16:19], v[176:191]
K2_S11:
  s_nop 8
  v_exp_f32 v144, v144
  v_exp_f32 v145, v145
  v_exp_f32 v146, v146
  v_exp_f32 v147, v147
  v_exp_f32 v148, v148
  v_exp_f32 v149, v149
  v_exp_f32 v150, v150
  v_exp_f32 v151, v151
  v_exp_f32 v152, v152
  v_exp_f32 v153, v153
  v_exp_f32 v154, v154
  v_exp_f32 v155, v155
  v_exp_f32 v156, v156
  v_exp_f32 v157, v157
  v_exp_f32 v158, v158
  v_exp_f32 v159, v159
  v_cvt_pk_bf16_f32 v208, v144, v145
  v_cvt_pk_bf16_f32 v209, v146, v147
  v_cvt_pk_bf16_f32 v210, v148, v149
  v_cvt_pk_bf16_f32 v211, v150, v151
  v_cvt_pk_bf16_f32 v212, v152, v153
  v_cvt_pk_bf16_f32 v213, v154, v155
  v_cvt_pk_bf16_f32 v214, v156, v157
  v_cvt_pk_bf16_f32 v215, v158, v159
  v_mfma_f32_32x32x16_bf16 v[216:231], v[128:131], v[208:211], 0
  s_nop 0
  v_mfma_f32_32x32x16_bf16 v[216:231], v[132:135], v[212:215], v[216:231]
  s_add_i32 s36, s41, 7
  s_cmp_lt_i32 s36, 0
  s_cbranch_scc1 K2_D10
  s_add_i32 s36, s41, 6
  s_cmp_lt_i32 s36, 0
  s_cbranch_scc1 K2_S12
  v_mfma_f32_32x32x16_bf16 v[144:159], v[48:51], v[16:19], v[176:191]
K2_S12:
  v_exp_f32 v160, v160
  v_exp_f32 v161, v161
  v_exp_f32 v162, v162
  v_exp_f32 v163, v163
  v_exp_f32 v164, v164
  v_exp_f32 v165, v165
  v_exp_f32 v166, v166
  v_exp_f32 v167, v167
  v_exp_f32 v168, v168
  v_exp_f32 v169, v169
  v_exp_f32 v170, v170
  v_exp_f32 v171, v171
  v_exp_f32 v172, v172
  v_exp_f32 v173, v173
  v_exp_f32 v174, v174
  v_exp_f32 v175, v175
  v_cvt_pk_bf16_f32 v208, v160, v161
  v_cvt_pk_bf16_f32 v209, v162, v163
  v_cvt_pk_bf16_f32 v210, v164, v165
  v_cvt_pk_bf16_f32 v211, v166, v167
  v_cvt_pk_bf16_f32 v212, v168, v169
  v_cvt_pk_bf16_f32 v213, v170, v171
  v_cvt_pk_bf16_f32 v214, v172, v173
  v_cvt_pk_bf16_f32 v215, v174, v175
  v_mfma_f32_32x32x16_bf16 v[216:231], v[120:123], v[208:211], v[216:231]
  s_nop 0
  v_mfma_f32_32x32x16_bf16 v[216:231], v[124:127], v[212:215], v[216:231]
  s_add_i32 s36, s41, 6
  s_cmp_lt_i32 s36, 0
  s_cbranch_scc1 K2_D10
  s_add_i32 s36, s41, 5
  s_cmp_lt_i32 s36, 0
  s_cbranch_scc1 K2_S13
  v_mfma_f32_32x32x16_bf16 v[160:175], v[44:47], v[16:19], v[176:191]
K2_S13:
  v_exp_f32 v144, v144
  v_exp_f32 v145, v145
  v_exp_f32 v146, v146
  v_exp_f32 v147, v147
  v_exp_f32 v148, v148
  v_exp_f32 v149, v149
  v_exp_f32 v150, v150
  v_exp_f32 v151, v151
  v_exp_f32 v152, v152
  v_exp_f32 v153, v153
  v_exp_f32 v154, v154
  v_exp_f32 v155, v155
  v_exp_f32 v156, v156
  v_exp_f32 v157, v157
  v_exp_f32 v158, v158
  v_exp_f32 v159, v159
  v_cvt_pk_bf16_f32 v208, v144, v145
  v_cvt_pk_bf16_f32 v209, v146, v147
  v_cvt_pk_bf16_f32 v210, v148, v149
  v_cvt_pk_bf16_f32 v211, v150, v151
  v_cvt_pk_bf16_f32 v212, v152, v153
  v_cvt_pk_bf16_f32 v213, v154, v155
  v_cvt_pk_bf16_f32 v214, v156, v157
  v_cvt_pk_bf16_f32 v215, v158, v159
  v_mfma_f32_32x32x16_bf16 v[216:231], v[112:115], v[208:211], v[216:231]
  s_nop 0
  v_mfma_f32_32x32x16_bf16 v[216:231], v[116:119], v[212:215], v[216:231]
  s_add_i32 s36, s41, 5
  s_cmp_lt_i32 s36, 0
  s_cbranch_scc1 K2_D10
  s_add_i32 s36, s41, 4
  s_cmp_lt_i32 s36, 0
  s_cbranch_scc1 K2_S14
  v_mfma_f32_32x32x16_bf16 v[144:159], v[40:43], v[16:19], v[176:191]
K2_S14:
  v_exp_f32 v160, v160
  v_exp_f32 v161, v161
  v_exp_f32 v162, v162
  v_exp_f32 v163, v163
  v_exp_f32 v164, v164
  v_exp_f32 v165, v165
  v_exp_f32 v166, v166
  v_exp_f32 v167, v167
  v_exp_f32 v168, v168
  v_exp_f32 v169, v169
  v_exp_f32 v170, v170
  v_exp_f32 v171, v171
  v_exp_f32 v172, v172
  v_exp_f32 v173, v173
  v_exp_f32 v174, v174
  v_exp_f32 v175, v175
  v_cvt_pk_bf16_f32 v208, v160, v161
  v_cvt_pk_bf16_f32 v209, v162, v163
  v_cvt_pk_bf16_f32 v210, v164, v165
  v_cvt_pk_bf16_f32 v211, v166, v167
  v_cvt_pk_bf16_f32 v212, v168, v169
  v_cvt_pk_bf16_f32 v213, v170, v171
  v_cvt_pk_bf16_f32 v214, v172, v173
  v_cvt_pk_bf16_f32 v215, v174, v175
  v_mfma_f32_32x32x16_bf16 v[216:231], v[104:107], v[208:211], v[216:231]
  s_nop 0
  v_mfma_f32_32x32x16_bf16 v[216:231], v[108:111], v[212:215], v[216:231]
  s_add_i32 s36, s41, 4
  s_cmp_lt_i32 s36, 0
  s_cbranch_scc1 K2_D10
  s_add_i32 s36, s41, 3
  s_cmp_lt_i32 s36, 0
  s_cbranch_scc1 K2_S15
  v_mfma_f32_32x32x16_bf16 v[160:175], v[36:39], v[16:19], v[176:191]
K2_S15:
  v_exp_f32 v144, v144
  v_exp_f32 v145, v145
  v_exp_f32 v146, v146
  v_exp_f32 v147, v147
  v_exp_f32 v148, v148
  v_exp_f32 v149, v149
  v_exp_f32 v150, v150
  v_exp_f32 v151, v151
  v_exp_f32 v152, v152
  v_exp_f32 v153, v153
  v_exp_f32 v154, v154
  v_exp_f32 v155, v155
  v_exp_f32 v156, v156
  v_exp_f32 v157, v157
  v_exp_f32 v158, v158
  v_exp_f32 v159, v159
  v_cvt_pk_bf16_f32 v208, v144, v145
  v_cvt_pk_bf16_f32 v209, v146, v147
  v_cvt_pk_bf16_f32 v210, v148, v149
  v_cvt_pk_bf16_f32 v211, v150, v151
  v_cvt_pk_bf16_f32 v212, v152, v153
  v_cvt_pk_bf16_f32 v213, v154, v155
  v_cvt_pk_bf16_f32 v214, v156, v157
  v_cvt_pk_bf16_f32 v215, v158, v159
  v_mfma_f32_32x32x16_bf16 v[216:231], v[96:99], v[208:211], v[216:231]
  s_nop 0
  v_mfma_f32_32x32x16_bf16 v[216:231], v[100:103], v[212:215], v[216:231]
  s_add_i32 s36, s41, 3
  s_cmp_lt_i32 s36, 0
  s_cbranch_scc1 K2_D10
  s_add_i32 s36, s41, 2
  s_cmp_lt_i32 s36, 0
  s_cbranch_scc1 K2_S16
  v_mfma_f32_32x32x16_bf16 v[144:159], v[32:35], v[16:19], v[176:191]
K2_S16:
  v_exp_f32 v160, v160
  v_exp_f32 v161, v161
  v_exp_f32 v162, v162
  v_exp_f32 v163, v163
  v_exp_f32 v164, v164
  v_exp_f32 v165, v165
  v_exp_f32 v166, v166
  v_exp_f32 v167, v167
  v_exp_f32 v168, v168
  v_exp_f32 v169, v169
  v_exp_f32 v170, v170
  v_exp_f32 v171, v171
  v_exp_f32 v172, v172
  v_exp_f32 v173, v173
  v_exp_f32 v174, v174
  v_exp_f32 v175, v175
  v_cvt_pk_bf16_f32 v208, v160, v161
  v_cvt_pk_bf16_f32 v209, v162, v163
  v_cvt_pk_bf16_f32 v210, v164, v165
  v_cvt_pk_bf16_f32 v211, v166, v167
  v_cvt_pk_bf16_f32 v212, v168, v169
  v_cvt_pk_bf16_f32 v213, v170, v171
  v_cvt_pk_bf16_f32 v214, v172, v173
  v_cvt_pk_bf16_f32 v215, v174, v175
  v_mfma_f32_32x32x16_bf16 v[216:231], v[88:91], v[208:211], v[216:231]
  s_nop 0
  v_mfma_f32_32x32x16_bf16 v[216:231], v[92:95], v[212:215], v[216:231]
  s_add_i32 s36, s41, 2
  s_cmp_lt_i32 s36, 0
  s_cbranch_scc1 K2_D10
  s_add_i32 s36, s41, 1
  s_cmp_lt_i32 s36, 0
  s_cbranch_scc1 K2_S17
  v_mfma_f32_32x32x16_bf16 v[160:175], v[28:31], v[16:19], v[176:191]
K2_S17:
  v_exp_f32 v144, v144
  v_exp_f32 v145, v145
  v_exp_f32 v146, v146
  v_exp_f32 v147, v147
  v_exp_f32 v148, v148
  v_exp_f32 v149, v149
  v_exp_f32 v150, v150
  v_exp_f32 v151, v151
  v_exp_f32 v152, v152
  v_exp_f32 v153, v153
  v_exp_f32 v154, v154
  v_exp_f32 v155, v155
  v_exp_f32 v156, v156
  v_exp_f32 v157, v157
  v_exp_f32 v158, v158
  v_exp_f32 v159, v159
  v_cvt_pk_bf16_f32 v208, v144, v145
  v_cvt_pk_bf16_f32 v209, v146, v147
  v_cvt_pk_bf16_f32 v210, v148, v149
  v_cvt_pk_bf16_f32 v211, v150, v151
  v_cvt_pk_bf16_f32 v212, v152, v153
  v_cvt_pk_bf16_f32 v213, v154, v155
  v_cvt_pk_bf16_f32 v214, v156, v157
  v_cvt_pk_bf16_f32 v215, v158, v159
  v_mfma_f32_32x32x16_bf16 v[216:231], v[80:83], v[208:211], v[216:231]
  s_nop 0
  v_mfma_f32_32x32x16_bf16 v[216:231], v[84:87], v[212:215], v[216:231]
  s_add_i32 s36, s41, 1
  s_cmp_lt_i32 s36, 0
  s_cbranch_scc1 K2_D10
  s_add_i32 s36, s41, 0
  s_cmp_lt_i32 s36, 0
  s_cbranch_scc1 K2_S18
  v_cndmask_b32 v192, v176, v4, s[64:65]
  v_cndmask_b32 v193, v176, v4, s[66:67]
  v_cndmask_b32 v194, v176, v4, s[68:69]
  v_cndmask_b32 v195, v176, v4, s[70:71]
  v_cndmask_b32 v196, v176, v4, s[72:73]
  v_cndmask_b32 v197, v176, v4, s[74:75]
  v_cndmask_b32 v198, v176, v4, s[76:77]
  v_cndmask_b32 v199, v176, v4, s[78:79]
  v_cndmask_b32 v200, v176, v4, s[80:81]
  v_cndmask_b32 v201, v176, v4, s[82:83]
  v_cndmask_b32 v202, v176, v4, s[84:85]
  v_cndmask_b32 v203, v176, v4, s[86:87]
  v_cndmask_b32 v204, v176, v4, s[88:89]
  v_cndmask_b32 v205, v176, v4, s[90:91]
  v_cndmask_b32 v206, v176, v4, s[92:93]
  v_cndmask_b32 v207, v176, v4, s[94:95]
  s_nop 1
  v_mfma_f32_32x32x16_bf16 v[144:159], v[24:27], v[16:19], v[192:207]
K2_S18:
  v_exp_f32 v160, v160
  v_exp_f32 v161, v161
  v_exp_f32 v162, v162
  v_exp_f32 v163, v163
  v_exp_f32 v164, v164
  v_exp_f32 v165, v165
  v_exp_f32 v166, v166
  v_exp_f32 v167, v167
  v_exp_f32 v168, v168
  v_exp_f32 v169, v169
  v_exp_f32 v170, v170
  v_exp_f32 v171, v171
  v_exp_f32 v172, v172
  v_exp_f32 v173, v173
  v_exp_f32 v174, v174
  v_exp_f32 v175, v175
  v_cvt_pk_bf16_f32 v208, v160, v161
  v_cvt_pk_bf16_f32 v209, v162, v163
  v_cvt_pk_bf16_f32 v210, v164, v165
  v_cvt_pk_bf16_f32 v211, v166, v167
  v_cvt_pk_bf16_f32 v212, v168, v169
  v_cvt_pk_bf16_f32 v213, v170, v171
  v_cvt_pk_bf16_f32 v214, v172, v173
  v_cvt_pk_bf16_f32 v215, v174, v175
  v_mfma_f32_32x32x16_bf16 v[216:231], v[72:75], v[208:211], v[216:231]
  s_nop 0
  v_mfma_f32_32x32x16_bf16 v[216:231], v[76:79], v[212:215], v[216:231]
  s_add_i32 s36, s41, 0
  s_cmp_lt_i32 s36, 0
  s_cbranch_scc1 K2_D10
  v_exp_f32 v144, v144
  v_exp_f32 v145, v145
  v_exp_f32 v146, v146
  v_exp_f32 v147, v147
  v_exp_f32 v148, v148
  v_exp_f32 v149, v149
  v_exp_f32 v150, v150
  v_exp_f32 v151, v151
  v_exp_f32 v152, v152
  v_exp_f32 v153, v153
  v_exp_f32 v154, v154
  v_exp_f32 v155, v155
  v_exp_f32 v156, v156
  v_exp_f32 v157, v157
  v_exp_f32 v158, v158
  v_exp_f32 v159, v159
  v_cvt_pk_bf16_f32 v208, v144, v145
  v_cvt_pk_bf16_f32 v209, v146, v147
  v_cvt_pk_bf16_f32 v210, v148, v149
  v_cvt_pk_bf16_f32 v211, v150, v151
  v_cvt_pk_bf16_f32 v212, v152, v153
  v_cvt_pk_bf16_f32 v213, v154, v155
  v_cvt_pk_bf16_f32 v214, v156, v157
  v_cvt_pk_bf16_f32 v215, v158, v159
  v_mfma_f32_32x32x16_bf16 v[216:231], v[64:67], v[208:211], v[216:231]
  s_nop 0
  v_mfma_f32_32x32x16_bf16 v[216:231], v[68:71], v[212:215], v[216:231]
K2_D10:
  s_nop 15
  v_rcp_f32 v6, v224
  s_nop 0
  v_mul_f32 v216, v216, v6
  v_mul_f32 v217, v217, v6
  v_mul_f32 v218, v218, v6
  v_mul_f32 v219, v219, v6
  v_mul_f32 v220, v220, v6
  v_mul_f32 v221, v221, v6
  v_mul_f32 v222, v222, v6
  v_mul_f32 v223, v223, v6
  v_cvt_pk_bf16_f32 v8, v216, v217
  v_cvt_pk_bf16_f32 v9, v218, v219
  v_cvt_pk_bf16_f32 v10, v220, v221
  v_cvt_pk_bf16_f32 v11, v222, v223
  s_lshl_b32 s36, s21, 6
  s_add_u32 s36, s36, s40
  s_lshl_b32 s36, s36, 10
  s_add_u32 s36, s36, 14680064
  buffer_store_dwordx4 v[8:11], v14, s[16:19], s36 offen sc1
  v_mov_b32 v5, v4
  v_cndmask_b32 v192, v4, 0, s[64:65]
  v_cndmask_b32 v193, v4, 0, s[66:67]
  v_cndmask_b32 v194, v4, 0, s[68:69]
  v_cndmask_b32 v195, v4, 0, s[70:71]
  v_cndmask_b32 v196, v4, 0, s[72:73]
  v_cndmask_b32 v197, v4, 0, s[74:75]
  v_cndmask_b32 v198, v4, 0, s[76:77]
  v_cndmask_b32 v199, v4, 0, s[78:79]
  v_cndmask_b32 v200, v4, 0, s[80:81]
  v_cndmask_b32 v201, v4, 0, s[82:83]
  v_cndmask_b32 v202, v4, 0, s[84:85]
  v_cndmask_b32 v203, v4, 0, s[86:87]
  v_cndmask_b32 v204, v4, 0, s[88:89]
  v_cndmask_b32 v205, v4, 0, s[90:91]
  v_cndmask_b32 v206, v4, 0, s[92:93]
  v_cndmask_b32 v207, v4, 0, s[94:95]
  s_nop 1
  v_mfma_f32_32x32x16_bf16 v[144:159], v[60:63], v[20:23], v[192:207]
  s_add_i32 s36, s41, 8
  s_cmp_lt_i32 s36, 0
  s_cbranch_scc1 K2_S20
  v_mfma_f32_32x32x16_bf16 v[160:175], v[56:59], v[20:23], 0
K2_S20:
  s_nop 8
  v_max3_f32 v5, v144, v145, v5
  v_max3_f32 v5, v146, v147, v5
  v_max3_f32 v5, v148, v149, v5
  v_max3_f32 v5, v150, v151, v5
  v_max3_f32 v5, v152, v153, v5
  v_max3_f32 v5, v154, v155, v5
  v_max3_f32 v5, v156, v157, v5
  v_max3_f32 v5, v158, v159, v5
  s_add_i32 s36, s41, 8
  s_cmp_lt_i32 s36, 0
  s_cbranch_scc1 K2_D19
  s_add_i32 s36, s41, 7
  s_cmp_lt_i32 s36, 0
  s_cbranch_scc1 K2_S21
  v_mfma_f32_32x32x16_bf16 v[144:159], v[52:55], v[20:23], 0
K2_S21:
  v_max3_f32 v5, v160, v161, v5
  v_max3_f32 v5, v162, v163, v5
  v_max3_f32 v5, v164, v165, v5
  v_max3_f32 v5, v166, v167, v5
  v_max3_f32 v5, v168, v169, v5
  v_max3_f32 v5, v170, v171, v5
  v_max3_f32 v5, v172, v173, v5
  v_max3_f32 v5, v174, v175, v5
  s_add_i32 s36, s41, 7
  s_cmp_lt_i32 s36, 0
  s_cbranch_scc1 K2_D19
  s_add_i32 s36, s41, 6
  s_cmp_lt_i32 s36, 0
  s_cbranch_scc1 K2_S22
  v_mfma_f32_32x32x16_bf16 v[160:175], v[48:51], v[20:23], 0
K2_S22:
  v_max3_f32 v5, v144, v145, v5
  v_max3_f32 v5, v146, v147, v5
  v_max3_f32 v5, v148, v149, v5
  v_max3_f32 v5, v150, v151, v5
  v_max3_f32 v5, v152, v153, v5
  v_max3_f32 v5, v154, v155, v5
  v_max3_f32 v5, v156, v157, v5
  v_max3_f32 v5, v158, v159, v5
  s_add_i32 s36, s41, 6
  s_cmp_lt_i32 s36, 0
  s_cbranch_scc1 K2_D19
  s_add_i32 s36, s41, 5
  s_cmp_lt_i32 s36, 0
  s_cbranch_scc1 K2_S23
  v_mfma_f32_32x32x16_bf16 v[144:159], v[44:47], v[20:23], 0
K2_S23:
  v_max3_f32 v5, v160, v161, v5
  v_max3_f32 v5, v162, v163, v5
  v_max3_f32 v5, v164, v165, v5
  v_max3_f32 v5, v166, v167, v5
  v_max3_f32 v5, v168, v169, v5
  v_max3_f32 v5, v170, v171, v5
  v_max3_f32 v5, v172, v173, v5
  v_max3_f32 v5, v174, v175, v5
  s_add_i32 s36, s41, 5
  s_cmp_lt_i32 s36, 0
  s_cbranch_scc1 K2_D19
  s_add_i32 s36, s41, 4
  s_cmp_lt_i32 s36, 0
  s_cbranch_scc1 K2_S24
  v_mfma_f32_32x32x16_bf16 v[160:175], v[40:43], v[20:23], 0
K2_S24:
  v_max3_f32 v5, v144, v145, v5
  v_max3_f32 v5, v146, v147, v5
  v_max3_f32 v5, v148, v149, v5
  v_max3_f32 v5, v150, v151, v5
  v_max3_f32 v5, v152, v153, v5
  v_max3_f32 v5, v154, v155, v5
  v_max3_f32 v5, v156, v157, v5
  v_max3_f32 v5, v158, v159, v5
  s_add_i32 s36, s41, 4
  s_cmp_lt_i32 s36, 0
  s_cbranch_scc1 K2_D19
  s_add_i32 s36, s41, 3
  s_cmp_lt_i32 s36, 0
  s_cbranch_scc1 K2_S25
  v_mfma_f32_32x32x16_bf16 v[144:159], v[36:39], v[20:23], 0
K2_S25:
  v_max3_f32 v5, v160, v161, v5
  v_max3_f32 v5, v162, v163, v5
  v_max3_f32 v5, v164, v165, v5
  v_max3_f32 v5, v166, v167, v5
  v_max3_f32 v5, v168, v169, v5
  v_max3_f32 v5, v170, v171, v5
  v_max3_f32 v5, v172, v173, v5
  v_max3_f32 v5, v174, v175, v5
  s_add_i32 s36, s41, 3
  s_cmp_lt_i32 s36, 0
  s_cbranch_scc1 K2_D19
  s_add_i32 s36, s41, 2
  s_cmp_lt_i32 s36, 0
  s_cbranch_scc1 K2_S26
  v_mfma_f32_32x32x16_bf16 v[160:175], v[32:35], v[20:23], 0
K2_S26:
  v_max3_f32 v5, v144, v145, v5
  v_max3_f32 v5, v146, v147, v5
  v_max3_f32 v5, v148, v149, v5
  v_max3_f32 v5, v150, v151, v5
  v_max3_f32 v5, v152, v153, v5
  v_max3_f32 v5, v154, v155, v5
  v_max3_f32 v5, v156, v157, v5
  v_max3_f32 v5, v158, v159, v5
  s_add_i32 s36, s41, 2
  s_cmp_lt_i32 s36, 0
  s_cbranch_scc1 K2_D19
  s_add_i32 s36, s41, 1
  s_cmp_lt_i32 s36, 0
  s_cbranch_scc1 K2_S27
  v_cndmask_b32 v192, 0, v4, s[64:65]
  v_cndmask_b32 v193, 0, v4, s[66:67]
  v_cndmask_b32 v194, 0, v4, s[68:69]
  v_cndmask_b32 v195, 0, v4, s[70:71]
  v_cndmask_b32 v196, 0, v4, s[72:73]
  v_cndmask_b32 v197, 0, v4, s[74:75]
  v_cndmask_b32 v198, 0, v4, s[76:77]
  v_cndmask_b32 v199, 0, v4, s[78:79]
  v_cndmask_b32 v200, 0, v4, s[80:81]
  v_cndmask_b32 v201, 0, v4, s[82:83]
  v_cndmask_b32 v202, 0, v4, s[84:85]
  v_cndmask_b32 v203, 0, v4, s[86:87]
  v_cndmask_b32 v204, 0, v4, s[88:89]
  v_cndmask_b32 v205, 0, v4, s[90:91]
  v_cndmask_b32 v206, 0, v4, s[92:93]
  v_cndmask_b32 v207, 0, v4, s[94:95]
  s_nop 1
  v_mfma_f32_32x32x16_bf16 v[144:159], v[28:31], v[20:23], v[192:207]
K2_S27:
  v_max3_f32 v5, v160, v161, v5
  v_max3_f32 v5, v162, v163, v5
  v_max3_f32 v5, v164, v165, v5
  v_max3_f32 v5, v166, v167, v5
  v_max3_f32 v5, v168, v169, v5
  v_max3_f32 v5, v170, v171, v5
  v_max3_f32 v5, v172, v173, v5
  v_max3_f32 v5, v174, v175, v5
  s_add_i32 s36, s41, 1
  s_cmp_lt_i32 s36, 0
  s_cbranch_scc1 K2_D19
  s_nop 0
  v_max3_f32 v5, v144, v145, v5
  v_max3_f32 v5, v146, v147, v5
  v_max3_f32 v5, v148, v149, v5
  v_max3_f32 v5, v150, v151, v5
  v_max3_f32 v5, v152, v153, v5
  v_max3_f32 v5, v154, v155, v5
  v_max3_f32 v5, v156, v157, v5
  v_max3_f32 v5, v158, v159, v5
K2_D19:
  s_nop 15
  v_mov_b32 v6, v5
  s_nop 1
  v_permlane32_swap_b32 v5, v6
  v_max_f32 v5, v5, v6
  v_sub_f32 v176, 0, v5
  v_mov_b32 v177, v176
  v_mov_b32 v178, v176
  v_mov_b32 v179, v176
  v_mov_b32 v180, v176
  v_mov_b32 v181, v176
  v_mov_b32 v182, v176
  v_mov_b32 v183, v176
  v_mov_b32 v184, v176
  v_mov_b32 v185, v176
  v_mov_b32 v186, v176
  v_mov_b32 v187, v176
  v_mov_b32 v188, v176
  v_mov_b32 v189, v176
  v_mov_b32 v190, v176
  v_mov_b32 v191, v176
  v_cndmask_b32 v192, v4, v176, s[64:65]
  v_cndmask_b32 v193, v4, v176, s[66:67]
  v_cndmask_b32 v194, v4, v176, s[68:69]
  v_cndmask_b32 v195, v4, v176, s[70:71]
  v_cndmask_b32 v196, v4, v176, s[72:73]
  v_cndmask_b32 v197, v4, v176, s[74:75]
  v_cndmask_b32 v198, v4, v176, s[76:77]
  v_cndmask_b32 v199, v4, v176, s[78:79]
  v_cndmask_b32 v200, v4, v176, s[80:81]
  v_cndmask_b32 v201, v4, v176, s[82:83]
  v_cndmask_b32 v202, v4, v176, s[84:85]
  v_cndmask_b32 v203, v4, v176, s[86:87]
  v_cndmask_b32 v204, v4, v176, s[88:89]
  v_cndmask_b32 v205, v4, v176, s[90:91]
  v_cndmask_b32 v206, v4, v176, s[92:93]
  v_cndmask_b32 v207, v4, v176, s[94:95]
  s_nop 1
  v_mfma_f32_32x32x16_bf16 v[144:159], v[60:63], v[20:23], v[192:207]
  s_add_i32 s36, s41, 8
  s_cmp_lt_i32 s36, 0
  s_cbranch_scc1 K2_S29
  v_mfma_f32_32x32x16_bf16 v[160:175], v[56:59], v[20:23], v[176:191]
K2_S29:
  s_nop 8
  v_exp_f32 v144, v144
  v_exp_f32 v145, v145
  v_exp_f32 v146, v146
  v_exp_f32 v147, v147
  v_exp_f32 v148, v148
  v_exp_f32 v149, v149
  v_exp_f32 v150, v150
  v_exp_f32 v151, v151
  v_exp_f32 v152, v152
  v_exp_f32 v153, v153
  v_exp_f32 v154, v154
  v_exp_f32 v155, v155
  v_exp_f32 v156, v156
  v_exp_f32 v157, v157
  v_exp_f32 v158, v158
  v_exp_f32 v159, v159
  v_cvt_pk_bf16_f32 v208, v144, v145
  v_cvt_pk_bf16_f32 v209, v146, v147
  v_cvt_pk_bf16_f32 v210, v148, v149
  v_cvt_pk_bf16_f32 v211, v150, v151
  v_cvt_pk_bf16_f32 v212, v152, v153
  v_cvt_pk_bf16_f32 v213, v154, v155
  v_cvt_pk_bf16_f32 v214, v156, v157
  v_cvt_pk_bf16_f32 v215, v158, v159
  v_mfma_f32_32x32x16_bf16 v[216:231], v[136:139], v[208:211], 0
  s_nop 0
  v_mfma_f32_32x32x16_bf16 v[216:231], v[140:143], v[212:215], v[216:231]
  s_add_i32 s36, s41, 8
  s_cmp_lt_i32 s36, 0
  s_cbranch_scc1 K2_D28
  s_add_i32 s36, s41, 7
  s_cmp_lt_i32 s36, 0
  s_cbranch_scc1 K2_S30
  v_mfma_f32_32x32x16_bf16 v[144:159], v[52:55], v[20:23], v[176:191]
K2_S30:
  v_exp_f32 v160, v160
  v_exp_f32 v161, v161
  v_exp_f32 v162, v162
  v_exp_f32 v163, v163
  v_exp_f32 v164, v164
  v_exp_f32 v165, v165
  v_exp_f32 v166, v166
  v_exp_f32 v167, v167
  v_exp_f32 v168, v168
  v_exp_f32 v169, v169
  v_exp_f32 v170, v170
  v_exp_f32 v171, v171
  v_exp_f32 v172, v172
  v_exp_f32 v173, v173
  v_exp_f32 v174, v174
  v_exp_f32 v175, v175
  v_cvt_pk_bf16_f32 v208, v160, v161
  v_cvt_pk_bf16_f32 v209, v162, v163
  v_cvt_pk_bf16_f32 v210, v164, v165
  v_cvt_pk_bf16_f32 v211, v166, v167
  v_cvt_pk_bf16_f32 v212, v168, v169
  v_cvt_pk_bf16_f32 v213, v170, v171
  v_cvt_pk_bf16_f32 v214, v172, v173
  v_cvt_pk_bf16_f32 v215, v174, v175
  v_mfma_f32_32x32x16_bf16 v[216:231], v[128:131], v[208:211], v[216:231]
  s_nop 0
  v_mfma_f32_32x32x16_bf16 v[216:231], v[132:135], v[212:215], v[216:231]
  s_add_i32 s36, s41, 7
  s_cmp_lt_i32 s36, 0
  s_cbranch_scc1 K2_D28
  s_add_i32 s36, s41, 6
  s_cmp_lt_i32 s36, 0
  s_cbranch_scc1 K2_S31
  v_mfma_f32_32x32x16_bf16 v[160:175], v[48:51], v[20:23], v[176:191]
K2_S31:
  v_exp_f32 v144, v144
  v_exp_f32 v145, v145
  v_exp_f32 v146, v146
  v_exp_f32 v147, v147
  v_exp_f32 v148, v148
  v_exp_f32 v149, v149
  v_exp_f32 v150, v150
  v_exp_f32 v151, v151
  v_exp_f32 v152, v152
  v_exp_f32 v153, v153
  v_exp_f32 v154, v154
  v_exp_f32 v155, v155
  v_exp_f32 v156, v156
  v_exp_f32 v157, v157
  v_exp_f32 v158, v158
  v_exp_f32 v159, v159
  v_cvt_pk_bf16_f32 v208, v144, v145
  v_cvt_pk_bf16_f32 v209, v146, v147
  v_cvt_pk_bf16_f32 v210, v148, v149
  v_cvt_pk_bf16_f32 v211, v150, v151
  v_cvt_pk_bf16_f32 v212, v152, v153
  v_cvt_pk_bf16_f32 v213, v154, v155
  v_cvt_pk_bf16_f32 v214, v156, v157
  v_cvt_pk_bf16_f32 v215, v158, v159
  v_mfma_f32_32x32x16_bf16 v[216:231], v[120:123], v[208:211], v[216:231]
  s_nop 0
  v_mfma_f32_32x32x16_bf16 v[216:231], v[124:127], v[212:215], v[216:231]
  s_add_i32 s36, s41, 6
  s_cmp_lt_i32 s36, 0
  s_cbranch_scc1 K2_D28
  s_add_i32 s36, s41, 5
  s_cmp_lt_i32 s36, 0
  s_cbranch_scc1 K2_S32
  v_mfma_f32_32x32x16_bf16 v[144:159], v[44:47], v[20:23], v[176:191]
K2_S32:
  v_exp_f32 v160, v160
  v_exp_f32 v161, v161
  v_exp_f32 v162, v162
  v_exp_f32 v163, v163
  v_exp_f32 v164, v164
  v_exp_f32 v165, v165
  v_exp_f32 v166, v166
  v_exp_f32 v167, v167
  v_exp_f32 v168, v168
  v_exp_f32 v169, v169
  v_exp_f32 v170, v170
  v_exp_f32 v171, v171
  v_exp_f32 v172, v172
  v_exp_f32 v173, v173
  v_exp_f32 v174, v174
  v_exp_f32 v175, v175
  v_cvt_pk_bf16_f32 v208, v160, v161
  v_cvt_pk_bf16_f32 v209, v162, v163
  v_cvt_pk_bf16_f32 v210, v164, v165
  v_cvt_pk_bf16_f32 v211, v166, v167
  v_cvt_pk_bf16_f32 v212, v168, v169
  v_cvt_pk_bf16_f32 v213, v170, v171
  v_cvt_pk_bf16_f32 v214, v172, v173
  v_cvt_pk_bf16_f32 v215, v174, v175
  v_mfma_f32_32x32x16_bf16 v[216:231], v[112:115], v[208:211], v[216:231]
  s_nop 0
  v_mfma_f32_32x32x16_bf16 v[216:231], v[116:119], v[212:215], v[216:231]
  s_add_i32 s36, s41, 5
  s_cmp_lt_i32 s36, 0
  s_cbranch_scc1 K2_D28
  s_add_i32 s36, s41, 4
  s_cmp_lt_i32 s36, 0
  s_cbranch_scc1 K2_S33
  v_mfma_f32_32x32x16_bf16 v[160:175], v[40:43], v[20:23], v[176:191]
K2_S33:
  v_exp_f32 v144, v144
  v_exp_f32 v145, v145
  v_exp_f32 v146, v146
  v_exp_f32 v147, v147
  v_exp_f32 v148, v148
  v_exp_f32 v149, v149
  v_exp_f32 v150, v150
  v_exp_f32 v151, v151
  v_exp_f32 v152, v152
  v_exp_f32 v153, v153
  v_exp_f32 v154, v154
  v_exp_f32 v155, v155
  v_exp_f32 v156, v156
  v_exp_f32 v157, v157
  v_exp_f32 v158, v158
  v_exp_f32 v159, v159
  v_cvt_pk_bf16_f32 v208, v144, v145
  v_cvt_pk_bf16_f32 v209, v146, v147
  v_cvt_pk_bf16_f32 v210, v148, v149
  v_cvt_pk_bf16_f32 v211, v150, v151
  v_cvt_pk_bf16_f32 v212, v152, v153
  v_cvt_pk_bf16_f32 v213, v154, v155
  v_cvt_pk_bf16_f32 v214, v156, v157
  v_cvt_pk_bf16_f32 v215, v158, v159
  v_mfma_f32_32x32x16_bf16 v[216:231], v[104:107], v[208:211], v[216:231]
  s_nop 0
  v_mfma_f32_32x32x16_bf16 v[216:231], v[108:111], v[212:215], v[216:231]
  s_add_i32 s36, s41, 4
  s_cmp_lt_i32 s36, 0
  s_cbranch_scc1 K2_D28
  s_add_i32 s36, s41, 3
  s_cmp_lt_i32 s36, 0
  s_cbranch_scc1 K2_S34
  v_mfma_f32_32x32x16_bf16 v[144:159], v[36:39], v[20:23], v[176:191]
K2_S34:
  v_exp_f32 v160, v160
  v_exp_f32 v161, v161
  v_exp_f32 v162, v162
  v_exp_f32 v163, v163
  v_exp_f32 v164, v164
  v_exp_f32 v165, v165
  v_exp_f32 v166, v166
  v_exp_f32 v167, v167
  v_exp_f32 v168, v168
  v_exp_f32 v169, v169
  v_exp_f32 v170, v170
  v_exp_f32 v171, v171
  v_exp_f32 v172, v172
  v_exp_f32 v173, v173
  v_exp_f32 v174, v174
  v_exp_f32 v175, v175
  v_cvt_pk_bf16_f32 v208, v160, v161
  v_cvt_pk_bf16_f32 v209, v162, v163
  v_cvt_pk_bf16_f32 v210, v164, v165
  v_cvt_pk_bf16_f32 v211, v166, v167
  v_cvt_pk_bf16_f32 v212, v168, v169
  v_cvt_pk_bf16_f32 v213, v170, v171
  v_cvt_pk_bf16_f32 v214, v172, v173
  v_cvt_pk_bf16_f32 v215, v174, v175
  v_mfma_f32_32x32x16_bf16 v[216:231], v[96:99], v[208:211], v[216:231]
  s_nop 0
  v_mfma_f32_32x32x16_bf16 v[216:231], v[100:103], v[212:215], v[216:231]
  s_add_i32 s36, s41, 3
  s_cmp_lt_i32 s36, 0
  s_cbranch_scc1 K2_D28
  s_add_i32 s36, s41, 2
  s_cmp_lt_i32 s36, 0
  s_cbranch_scc1 K2_S35
  v_mfma_f32_32x32x16_bf16 v[160:175], v[32:35], v[20:23], v[176:191]
K2_S35:
  v_exp_f32 v144, v144
  v_exp_f32 v145, v145
  v_exp_f32 v146, v146
  v_exp_f32 v147, v147
  v_exp_f32 v148, v148
  v_exp_f32 v149, v149
  v_exp_f32 v150, v150
  v_exp_f32 v151, v151
  v_exp_f32 v152, v152
  v_exp_f32 v153, v153
  v_exp_f32 v154, v154
  v_exp_f32 v155, v155
  v_exp_f32 v156, v156
  v_exp_f32 v157, v157
  v_exp_f32 v158, v158
  v_exp_f32 v159, v159
  v_cvt_pk_bf16_f32 v208, v144, v145
  v_cvt_pk_bf16_f32 v209, v146, v147
  v_cvt_pk_bf16_f32 v210, v148, v149
  v_cvt_pk_bf16_f32 v211, v150, v151
  v_cvt_pk_bf16_f32 v212, v152, v153
  v_cvt_pk_bf16_f32 v213, v154, v155
  v_cvt_pk_bf16_f32 v214, v156, v157
  v_cvt_pk_bf16_f32 v215, v158, v159
  v_mfma_f32_32x32x16_bf16 v[216:231], v[88:91], v[208:211], v[216:231]
  s_nop 0
  v_mfma_f32_32x32x16_bf16 v[216:231], v[92:95], v[212:215], v[216:231]
  s_add_i32 s36, s41, 2
  s_cmp_lt_i32 s36, 0
  s_cbranch_scc1 K2_D28
  s_add_i32 s36, s41, 1
  s_cmp_lt_i32 s36, 0
  s_cbranch_scc1 K2_S36
  v_cndmask_b32 v192, v176, v4, s[64:65]
  v_cndmask_b32 v193, v176, v4, s[66:67]
  v_cndmask_b32 v194, v176, v4, s[68:69]
  v_cndmask_b32 v195, v176, v4, s[70:71]
  v_cndmask_b32 v196, v176, v4, s[72:73]
  v_cndmask_b32 v197, v176, v4, s[74:75]
  v_cndmask_b32 v198, v176, v4, s[76:77]
  v_cndmask_b32 v199, v176, v4, s[78:79]
  v_cndmask_b32 v200, v176, v4, s[80:81]
  v_cndmask_b32 v201, v176, v4, s[82:83]
  v_cndmask_b32 v202, v176, v4, s[84:85]
  v_cndmask_b32 v203, v176, v4, s[86:87]
  v_cndmask_b32 v204, v176, v4, s[88:89]
  v_cndmask_b32 v205, v176, v4, s[90:91]
  v_cndmask_b32 v206, v176, v4, s[92:93]
  v_cndmask_b32 v207, v176, v4, s[94:95]
  s_nop 1
  v_mfma_f32_32x32x16_bf16 v[144:159], v[28:31], v[20:23], v[192:207]
K2_S36:
  v_exp_f32 v160, v160
  v_exp_f32 v161, v161
  v_exp_f32 v162, v162
  v_exp_f32 v163, v163
  v_exp_f32 v164, v164
  v_exp_f32 v165, v165
  v_exp_f32 v166, v166
  v_exp_f32 v167, v167
  v_exp_f32 v168, v168
  v_exp_f32 v169, v169
  v_exp_f32 v170, v170
  v_exp_f32 v171, v171
  v_exp_f32 v172, v172
  v_exp_f32 v173, v173
  v_exp_f32 v174, v174
  v_exp_f32 v175, v175
  v_cvt_pk_bf16_f32 v208, v160, v161
  v_cvt_pk_bf16_f32 v209, v162, v163
  v_cvt_pk_bf16_f32 v210, v164, v165
  v_cvt_pk_bf16_f32 v211, v166, v167
  v_cvt_pk_bf16_f32 v212, v168, v169
  v_cvt_pk_bf16_f32 v213, v170, v171
  v_cvt_pk_bf16_f32 v214, v172, v173
  v_cvt_pk_bf16_f32 v215, v174, v175
  v_mfma_f32_32x32x16_bf16 v[216:231], v[80:83], v[208:211], v[216:231]
  s_nop 0
  v_mfma_f32_32x32x16_bf16 v[216:231], v[84:87], v[212:215], v[216:231]
  s_add_i32 s36, s41, 1
  s_cmp_lt_i32 s36, 0
  s_cbranch_scc1 K2_D28
  v_exp_f32 v144, v144
  v_exp_f32 v145, v145
  v_exp_f32 v146, v146
  v_exp_f32 v147, v147
  v_exp_f32 v148, v148
  v_exp_f32 v149, v149
  v_exp_f32 v150, v150
  v_exp_f32 v151, v151
  v_exp_f32 v152, v152
  v_exp_f32 v153, v153
  v_exp_f32 v154, v154
  v_exp_f32 v155, v155
  v_exp_f32 v156, v156
  v_exp_f32 v157, v157
  v_exp_f32 v158, v158
  v_exp_f32 v159, v159
  v_cvt_pk_bf16_f32 v208, v144, v145
  v_cvt_pk_bf16_f32 v209, v146, v147
  v_cvt_pk_bf16_f32 v210, v148, v149
  v_cvt_pk_bf16_f32 v211, v150, v151
  v_cvt_pk_bf16_f32 v212, v152, v153
  v_cvt_pk_bf16_f32 v213, v154, v155
  v_cvt_pk_bf16_f32 v214, v156, v157
  v_cvt_pk_bf16_f32 v215, v158, v159
  v_mfma_f32_32x32x16_bf16 v[216:231], v[72:75], v[208:211], v[216:231]
  s_nop 0
  v_mfma_f32_32x32x16_bf16 v[216:231], v[76:79], v[212:215], v[216:231]
K2_D28:
  s_nop 15
  v_rcp_f32 v6, v224
  s_nop 0
  v_mul_f32 v216, v216, v6
  v_mul_f32 v217, v217, v6
  v_mul_f32 v218, v218, v6
  v_mul_f32 v219, v219, v6
  v_mul_f32 v220, v220, v6
  v_mul_f32 v221, v221, v6
  v_mul_f32 v222, v222, v6
  v_mul_f32 v223, v223, v6
  v_cvt_pk_bf16_f32 v8, v216, v217
  v_cvt_pk_bf16_f32 v9, v218, v219
  v_cvt_pk_bf16_f32 v10, v220, v221
  v_cvt_pk_bf16_f32 v11, v222, v223
  s_lshl_b32 s36, s21, 6
  s_add_u32 s36, s36, s40
  s_lshl_b32 s36, s36, 10
  s_add_u32 s36, s36, 14712832
  buffer_store_dwordx4 v[8:11], v14, s[16:19], s36 offen sc1
  s_branch K2_AJOIN
K2_AFAST:
  v_mov_b32 v5, v4
  s_waitcnt vmcnt(10)
  v_cndmask_b32 v192, v4, 0, s[64:65]
  v_cndmask_b32 v193, v4, 0, s[66:67]
  v_cndmask_b32 v194, v4, 0, s[68:69]
  v_cndmask_b32 v195, v4, 0, s[70:71]
  v_cndmask_b32 v196, v4, 0, s[72:73]
  v_cndmask_b32 v197, v4, 0, s[74:75]
  v_cndmask_b32 v198, v4, 0, s[76:77]
  v_cndmask_b32 v199, v4, 0, s[78:79]
  v_cndmask_b32 v200, v4, 0, s[80:81]
  v_cndmask_b32 v201, v4, 0, s[82:83]
  v_cndmask_b32 v202, v4, 0, s[84:85]
  v_cndmask_b32 v203, v4, 0, s[86:87]
  v_cndmask_b32 v204, v4, 0, s[88:89]
  v_cndmask_b32 v205, v4, 0, s[90:91]
  v_cndmask_b32 v206, v4, 0, s[92:93]
  v_cndmask_b32 v207, v4, 0, s[94:95]
  s_nop 1
  v_mfma_f32_32x32x16_bf16 v[144:159], v[56:59], v[16:19], v[192:207]
  s_waitcnt vmcnt(9)
  v_mfma_f32_32x32x16_bf16 v[160:175], v[52:55], v[16:19], 0
  s_nop 9
  v_max3_f32 v5, v144, v145, v5
  v_max3_f32 v5, v146, v147, v5
  v_max3_f32 v5, v148, v149, v5
  v_max3_f32 v5, v150, v151, v5
  v_max3_f32 v5, v152, v153, v5
  v_max3_f32 v5, v154, v155, v5
  v_max3_f32 v5, v156, v157, v5
  v_max3_f32 v5, v158, v159, v5
  s_add_u32 s36, s52, 4194304
  buffer_load_dwordx4 v[128:131], v1, s[16:19], s36 offen
  s_waitcnt vmcnt(9)
  v_mfma_f32_32x32x16_bf16 v[144:159], v[48:51], v[16:19], 0
  v_max3_f32 v5, v160, v161, v5
  v_max3_f32 v5, v162, v163, v5
  v_max3_f32 v5, v164, v165, v5
  v_max3_f32 v5, v166, v167, v5
  v_max3_f32 v5, v168, v169, v5
  v_max3_f32 v5, v170, v171, v5
  v_max3_f32 v5, v172, v173, v5
  v_max3_f32 v5, v174, v175, v5
  s_add_u32 s36, s51, 4194304
  buffer_load_dwordx4 v[120:123], v1, s[16:19], s36 offen
  s_waitcnt vmcnt(9)
  v_mfma_f32_32x32x16_bf16 v[160:175], v[44:47], v[16:19], 0
  v_max3_f32 v5, v144, v145, v5
  v_max3_f32 v5, v146, v147, v5
  v_max3_f32 v5, v148, v149, v5
  v_max3_f32 v5, v150, v151, v5
  v_max3_f32 v5, v152, v153, v5
  v_max3_f32 v5, v154, v155, v5
  v_max3_f32 v5, v156, v157, v5
  v_max3_f32 v5, v158, v159, v5
  s_add_u32 s36, s50, 4194304
  buffer_load_dwordx4 v[112:115], v1, s[16:19], s36 offen
  s_waitcnt vmcnt(9)
  v_mfma_f32_32x32x16_bf16 v[144:159], v[40:43], v[16:19], 0
  v_max3_f32 v5, v160, v161, v5
  v_max3_f32 v5, v162, v163, v5
  v_max3_f32 v5, v164, v165, v5
  v_max3_f32 v5, v166, v167, v5
  v_max3_f32 v5, v168, v169, v5
  v_max3_f32 v5, v170, v171, v5
  v_max3_f32 v5, v172, v173, v5
  v_max3_f32 v5, v174, v175, v5
  s_add_u32 s36, s49, 4194304
  buffer_load_dwordx4 v[104:107], v1, s[16:19], s36 offen
  s_waitcnt vmcnt(9)
  v_mfma_f32_32x32x16_bf16 v[160:175], v[36:39], v[16:19], 0
  v_max3_f32 v5, v144, v145, v5
  v_max3_f32 v5, v146, v147, v5
  v_max3_f32 v5, v148, v149, v5
  v_max3_f32 v5, v150, v151, v5
  v_max3_f32 v5, v152, v153, v5
  v_max3_f32 v5, v154, v155, v5
  v_max3_f32 v5, v156, v157, v5
  v_max3_f32 v5, v158, v159, v5
  s_add_u32 s36, s48, 4194304
  buffer_load_dwordx4 v[96:99], v1, s[16:19], s36 offen
  s_waitcnt vmcnt(9)
  v_mfma_f32_32x32x16_bf16 v[144:159], v[32:35], v[16:19], 0
  v_max3_f32 v5, v160, v161, v5
  v_max3_f32 v5, v162, v163, v5
  v_max3_f32 v5, v164, v165, v5
  v_max3_f32 v5, v166, v167, v5
  v_max3_f32 v5, v168, v169, v5
  v_max3_f32 v5, v170, v171, v5
  v_max3_f32 v5, v172, v173, v5
  v_max3_f32 v5, v174, v175, v5
  s_add_u32 s36, s47, 4194304
  buffer_load_dwordx4 v[88:91], v1, s[16:19], s36 offen
  s_waitcnt vmcnt(9)
  v_mfma_f32_32x32x16_bf16 v[160:175], v[28:31], v[16:19], 0
  v_max3_f32 v5, v144, v145, v5
  v_max3_f32 v5, v146, v147, v5
  v_max3_f32 v5, v148, v149, v5
  v_max3_f32 v5, v150, v151, v5
  v_max3_f32 v5, v152, v153, v5
  v_max3_f32 v5, v154, v155, v5
  v_max3_f32 v5, v156, v157, v5
  v_max3_f32 v5, v158, v159, v5
  s_add_u32 s36, s46, 4194304
  buffer_load_dwordx4 v[80:83], v1, s[16:19], s36 offen
  s_add_u32 s36, s45, 4194304
  buffer_load_dwordx4 v[72:75], v1, s[16:19], s36 offen
  s_waitcnt vmcnt(10)
  v_cndmask_b32 v192, 0, v4, s[64:65]
  v_cndmask_b32 v193, 0, v4, s[66:67]
  v_cndmask_b32 v194, 0, v4, s[68:69]
  v_cndmask_b32 v195, 0, v4, s[70:71]
  v_cndmask_b32 v196, 0, v4, s[72:73]
  v_cndmask_b32 v197, 0, v4, s[74:75]
  v_cndmask_b32 v198, 0, v4, s[76:77]
  v_cndmask_b32 v199, 0, v4, s[78:79]
  v_cndmask_b32 v200, 0, v4, s[80:81]
  v_cndmask_b32 v201, 0, v4, s[82:83]
  v_cndmask_b32 v202, 0, v4, s[84:85]
  v_cndmask_b32 v203, 0, v4, s[86:87]
  v_cndmask_b32 v204, 0, v4, s[88:89]
  v_cndmask_b32 v205, 0, v4, s[90:91]
  v_cndmask_b32 v206, 0, v4, s[92:93]
  v_cndmask_b32 v207, 0, v4, s[94:95]
  s_nop 1
  v_mfma_f32_32x32x16_bf16 v[144:159], v[24:27], v[16:19], v[192:207]
  v_max3_f32 v5, v160, v161, v5
  v_max3_f32 v5, v162, v163, v5
  v_max3_f32 v5, v164, v165, v5
  v_max3_f32 v5, v166, v167, v5
  v_max3_f32 v5, v168, v169, v5
  v_max3_f32 v5, v170, v171, v5
  v_max3_f32 v5, v172, v173, v5
  v_max3_f32 v5, v174, v175, v5
  s_add_u32 s36, s44, 4194304
  buffer_load_dwordx4 v[64:67], v1, s[16:19], s36 offen
  s_add_u32 s36, s53, 4194304
  buffer_load_dwordx4 v[136:139], v1, s[16:19], s36 offen
  v_max3_f32 v5, v144, v145, v5
  v_max3_f32 v5, v146, v147, v5
  v_max3_f32 v5, v148, v149, v5
  v_max3_f32 v5, v150, v151, v5
  v_max3_f32 v5, v152, v153, v5
  v_max3_f32 v5, v154, v155, v5
  v_max3_f32 v5, v156, v157, v5
  v_max3_f32 v5, v158, v159, v5
  buffer_load_dwordx4 v[232:235], v13, s[4:7], s23 offen
  v_mov_b32 v6, v5
  s_nop 1
  v_permlane32_swap_b32 v5, v6
  v_max_f32 v5, v5, v6
  v_sub_f32 v176, 0, v5
  v_mov_b32 v177, v176
  v_mov_b32 v178, v176
  v_mov_b32 v179, v176
  v_mov_b32 v180, v176
  v_mov_b32 v181, v176
  v_mov_b32 v182, v176
  v_mov_b32 v183, v176
  v_mov_b32 v184, v176
  v_mov_b32 v185, v176
  v_mov_b32 v186, v176
  v_mov_b32 v187, v176
  v_mov_b32 v188, v176
  v_mov_b32 v189, v176
  v_mov_b32 v190, v176
  v_mov_b32 v191, v176
  v_cndmask_b32 v192, v4, v176, s[64:65]
  v_cndmask_b32 v193, v4, v176, s[66:67]
  v_cndmask_b32 v194, v4, v176, s[68:69]
  v_cndmask_b32 v195, v4, v176, s[70:71]
  v_cndmask_b32 v196, v4, v176, s[72:73]
  v_cndmask_b32 v197, v4, v176, s[74:75]
  v_cndmask_b32 v198, v4, v176, s[76:77]
  v_cndmask_b32 v199, v4, v176, s[78:79]
  v_cndmask_b32 v200, v4, v176, s[80:81]
  v_cndmask_b32 v201, v4, v176, s[82:83]
  v_cndmask_b32 v202, v4, v176, s[84:85]
  v_cndmask_b32 v203, v4, v176, s[86:87]
  v_cndmask_b32 v204, v4, v176, s[88:89]
  v_cndmask_b32 v205, v4, v176, s[90:91]
  v_cndmask_b32 v206, v4, v176, s[92:93]
  v_cndmask_b32 v207, v4, v176, s[94:95]
  s_nop 1
  v_mfma_f32_32x32x16_bf16 v[144:159], v[56:59], v[16:19], v[192:207]
  v_mfma_f32_32x32x16_bf16 v[160:175], v[52:55], v[16:19], v[176:191]
  s_waitcnt vmcnt(10)
  v_permlane16_swap_b32 v128, v132
  v_permlane16_swap_b32 v129, v133
  v_permlane16_swap_b32 v130, v134
  v_permlane16_swap_b32 v131, v135
  s_nop 5
  v_exp_f32 v144, v144
  v_exp_f32 v145, v145
  v_exp_f32 v146, v146
  v_exp_f32 v147, v147
  v_exp_f32 v148, v148
  v_exp_f32 v149, v149
  v_exp_f32 v150, v150
  v_exp_f32 v151, v151
  v_exp_f32 v152, v152
  v_exp_f32 v153, v153
  v_exp_f32 v154, v154
  v_exp_f32 v155, v155
  v_exp_f32 v156, v156
  v_exp_f32 v157, v157
  v_exp_f32 v158, v158
  v_exp_f32 v159, v159
  v_cvt_pk_bf16_f32 v208, v144, v145
  v_cvt_pk_bf16_f32 v209, v146, v147
  v_cvt_pk_bf16_f32 v210, v148, v149
  v_cvt_pk_bf16_f32 v211, v150, v151
  v_cvt_pk_bf16_f32 v212, v152, v153
  v_cvt_pk_bf16_f32 v213, v154, v155
  v_cvt_pk_bf16_f32 v214, v156, v157
  v_cvt_pk_bf16_f32 v215, v158, v159
  v_mfma_f32_32x32x16_bf16 v[216:231], v[128:131], v[208:211], 0
  s_nop 0
  v_mfma_f32_32x32x16_bf16 v[216:231], v[132:135], v[212:215], v[216:231]
  v_mfma_f32_32x32x16_bf16 v[144:159], v[48:51], v[16:19], v[176:191]
  s_waitcnt vmcnt(9)
  v_permlane16_swap_b32 v120, v124
  v_permlane16_swap_b32 v121, v125
  v_permlane16_swap_b32 v122, v126
  v_permlane16_swap_b32 v123, v127
  v_exp_f32 v160, v160
  v_exp_f32 v161, v161
  v_exp_f32 v162, v162
  v_exp_f32 v163, v163
  v_exp_f32 v164, v164
  v_exp_f32 v165, v165
  v_exp_f32 v166, v166
  v_exp_f32 v167, v167
  v_exp_f32 v168, v168
  v_exp_f32 v169, v169
  v_exp_f32 v170, v170
  v_exp_f32 v171, v171
  v_exp_f32 v172, v172
  v_exp_f32 v173, v173
  v_exp_f32 v174, v174
  v_exp_f32 v175, v175
  v_cvt_pk_bf16_f32 v208, v160, v161
  v_cvt_pk_bf16_f32 v209, v162, v163
  v_cvt_pk_bf16_f32 v210, v164, v165
  v_cvt_pk_bf16_f32 v211, v166, v167
  v_cvt_pk_bf16_f32 v212, v168, v169
  v_cvt_pk_bf16_f32 v213, v170, v171
  v_cvt_pk_bf16_f32 v214, v172, v173
  v_cvt_pk_bf16_f32 v215, v174, v175
  v_mfma_f32_32x32x16_bf16 v[216:231], v[120:123], v[208:211], v[216:231]
  s_nop 0
  v_mfma_f32_32x32x16_bf16 v[216:231], v[124:127], v[212:215], v[216:231]
  v_mfma_f32_32x32x16_bf16 v[160:175], v[44:47], v[16:19], v[176:191]
  s_waitcnt vmcnt(8)
  v_permlane16_swap_b32 v112, v116
  v_permlane16_swap_b32 v113, v117
  v_permlane16_swap_b32 v114, v118
  v_permlane16_swap_b32 v115, v119
  v_exp_f32 v144, v144
  v_exp_f32 v145, v145
  v_exp_f32 v146, v146
  v_exp_f32 v147, v147
  v_exp_f32 v148, v148
  v_exp_f32 v149, v149
  v_exp_f32 v150, v150
  v_exp_f32 v151, v151
  v_exp_f32 v152, v152
  v_exp_f32 v153, v153
  v_exp_f32 v154, v154
  v_exp_f32 v155, v155
  v_exp_f32 v156, v156
  v_exp_f32 v157, v157
  v_exp_f32 v158, v158
  v_exp_f32 v159, v159
  v_cvt_pk_bf16_f32 v208, v144, v145
  v_cvt_pk_bf16_f32 v209, v146, v147
  v_cvt_pk_bf16_f32 v210, v148, v149
  v_cvt_pk_bf16_f32 v211, v150, v151
  v_cvt_pk_bf16_f32 v212, v152, v153
  v_cvt_pk_bf16_f32 v213, v154, v155
  v_cvt_pk_bf16_f32 v214, v156, v157
  v_cvt_pk_bf16_f32 v215, v158, v159
  v_mfma_f32_32x32x16_bf16 v[216:231], v[112:115], v[208:211], v[216:231]
  s_nop 0
  v_mfma_f32_32x32x16_bf16 v[216:231], v[116:119], v[212:215], v[216:231]
  v_mfma_f32_32x32x16_bf16 v[144:159], v[40:43], v[16:19], v[176:191]
  s_waitcnt vmcnt(7)
  v_permlane16_swap_b32 v104, v108
  v_permlane16_swap_b32 v105, v109
  v_permlane16_swap_b32 v106, v110
  v_permlane16_swap_b32 v107, v111
  v_exp_f32 v160, v160
  v_exp_f32 v161, v161
  v_exp_f32 v162, v162
  v_exp_f32 v163, v163
  v_exp_f32 v164, v164
  v_exp_f32 v165, v165
  v_exp_f32 v166, v166
  v_exp_f32 v167, v167
  v_exp_f32 v168, v168
  v_exp_f32 v169, v169
  v_exp_f32 v170, v170
  v_exp_f32 v171, v171
  v_exp_f32 v172, v172
  v_exp_f32 v173, v173
  v_exp_f32 v174, v174
  v_exp_f32 v175, v175
  v_cvt_pk_bf16_f32 v208, v160, v161
  v_cvt_pk_bf16_f32 v209, v162, v163
  v_cvt_pk_bf16_f32 v210, v164, v165
  v_cvt_pk_bf16_f32 v211, v166, v167
  v_cvt_pk_bf16_f32 v212, v168, v169
  v_cvt_pk_bf16_f32 v213, v170, v171
  v_cvt_pk_bf16_f32 v214, v172, v173
  v_cvt_pk_bf16_f32 v215, v174, v175
  v_mfma_f32_32x32x16_bf16 v[216:231], v[104:107], v[208:211], v[216:231]
  s_nop 0
  v_mfma_f32_32x32x16_bf16 v[216:231], v[108:111], v[212:215], v[216:231]
  v_mfma_f32_32x32x16_bf16 v[160:175], v[36:39], v[16:19], v[176:191]
  s_waitcnt vmcnt(6)
  v_permlane16_swap_b32 v96, v100
  v_permlane16_swap_b32 v97, v101
  v_permlane16_swap_b32 v98, v102
  v_permlane16_swap_b32 v99, v103
  v_exp_f32 v144, v144
  v_exp_f32 v145, v145
  v_exp_f32 v146, v146
  v_exp_f32 v147, v147
  v_exp_f32 v148, v148
  v_exp_f32 v149, v149
  v_exp_f32 v150, v150
  v_exp_f32 v151, v151
  v_exp_f32 v152, v152
  v_exp_f32 v153, v153
  v_exp_f32 v154, v154
  v_exp_f32 v155, v155
  v_exp_f32 v156, v156
  v_exp_f32 v157, v157
  v_exp_f32 v158, v158
  v_exp_f32 v159, v159
  v_cvt_pk_bf16_f32 v208, v144, v145
  v_cvt_pk_bf16_f32 v209, v146, v147
  v_cvt_pk_bf16_f32 v210, v148, v149
  v_cvt_pk_bf16_f32 v211, v150, v151
  v_cvt_pk_bf16_f32 v212, v152, v153
  v_cvt_pk_bf16_f32 v213, v154, v155
  v_cvt_pk_bf16_f32 v214, v156, v157
  v_cvt_pk_bf16_f32 v215, v158, v159
  v_mfma_f32_32x32x16_bf16 v[216:231], v[96:99], v[208:211], v[216:231]
  s_nop 0
  v_mfma_f32_32x32x16_bf16 v[216:231], v[100:103], v[212:215], v[216:231]
  v_mfma_f32_32x32x16_bf16 v[144:159], v[32:35], v[16:19], v[176:191]
  s_waitcnt vmcnt(5)
  v_permlane16_swap_b32 v88, v92
  v_permlane16_swap_b32 v89, v93
  v_permlane16_swap_b32 v90, v94
  v_permlane16_swap_b32 v91, v95
  v_exp_f32 v160, v160
  v_exp_f32 v161, v161
  v_exp_f32 v162, v162
  v_exp_f32 v163, v163
  v_exp_f32 v164, v164
  v_exp_f32 v165, v165
  v_exp_f32 v166, v166
  v_exp_f32 v167, v167
  v_exp_f32 v168, v168
  v_exp_f32 v169, v169
  v_exp_f32 v170, v170
  v_exp_f32 v171, v171
  v_exp_f32 v172, v172
  v_exp_f32 v173, v173
  v_exp_f32 v174, v174
  v_exp_f32 v175, v175
  v_cvt_pk_bf16_f32 v208, v160, v161
  v_cvt_pk_bf16_f32 v209, v162, v163
  v_cvt_pk_bf16_f32 v210, v164, v165
  v_cvt_pk_bf16_f32 v211, v166, v167
  v_cvt_pk_bf16_f32 v212, v168, v169
  v_cvt_pk_bf16_f32 v213, v170, v171
  v_cvt_pk_bf16_f32 v214, v172, v173
  v_cvt_pk_bf16_f32 v215, v174, v175
  v_mfma_f32_32x32x16_bf16 v[216:231], v[88:91], v[208:211], v[216:231]
  s_nop 0
  v_mfma_f32_32x32x16_bf16 v[216:231], v[92:95], v[212:215], v[216:231]
  v_mfma_f32_32x32x16_bf16 v[160:175], v[28:31], v[16:19], v[176:191]
  s_waitcnt vmcnt(4)
  v_permlane16_swap_b32 v80, v84
  v_permlane16_swap_b32 v81, v85
  v_permlane16_swap_b32 v82, v86
  v_permlane16_swap_b32 v83, v87
  v_exp_f32 v144, v144
  v_exp_f32 v145, v145
  v_exp_f32 v146, v146
  v_exp_f32 v147, v147
  v_exp_f32 v148, v148
  v_exp_f32 v149, v149
  v_exp_f32 v150, v150
  v_exp_f32 v151, v151
  v_exp_f32 v152, v152
  v_exp_f32 v153, v153
  v_exp_f32 v154, v154
  v_exp_f32 v155, v155
  v_exp_f32 v156, v156
  v_exp_f32 v157, v157
  v_exp_f32 v158, v158
  v_exp_f32 v159, v159
  v_cvt_pk_bf16_f32 v208, v144, v145
  v_cvt_pk_bf16_f32 v209, v146, v147
  v_cvt_pk_bf16_f32 v210, v148, v149
  v_cvt_pk_bf16_f32 v211, v150, v151
  v_cvt_pk_bf16_f32 v212, v152, v153
  v_cvt_pk_bf16_f32 v213, v154, v155
  v_cvt_pk_bf16_f32 v214, v156, v157
  v_cvt_pk_bf16_f32 v215, v158, v159
  v_mfma_f32_32x32x16_bf16 v[216:231], v[80:83], v[208:211], v[216:231]
  s_nop 0
  v_mfma_f32_32x32x16_bf16 v[216:231], v[84:87], v[212:215], v[216:231]
  v_cndmask_b32 v192, v176, v4, s[64:65]
  v_cndmask_b32 v193, v176, v4, s[66:67]
  v_cndmask_b32 v194, v176, v4, s[68:69]
  v_cndmask_b32 v195, v176, v4, s[70:71]
  v_cndmask_b32 v196, v176, v4, s[72:73]
  v_cndmask_b32 v197, v176, v4, s[74:75]
  v_cndmask_b32 v198, v176, v4, s[76:77]
  v_cndmask_b32 v199, v176, v4, s[78:79]
  v_cndmask_b32 v200, v176, v4, s[80:81]
  v_cndmask_b32 v201, v176, v4, s[82:83]
  v_cndmask_b32 v202, v176, v4, s[84:85]
  v_cndmask_b32 v203, v176, v4, s[86:87]
  v_cndmask_b32 v204, v176, v4, s[88:89]
  v_cndmask_b32 v205, v176, v4, s[90:91]
  v_cndmask_b32 v206, v176, v4, s[92:93]
  v_cndmask_b32 v207, v176, v4, s[94:95]
  s_nop 1
  v_mfma_f32_32x32x16_bf16 v[144:159], v[24:27], v[16:19], v[192:207]
  s_waitcnt vmcnt(3)
  v_permlane16_swap_b32 v72, v76
  v_permlane16_swap_b32 v73, v77
  v_permlane16_swap_b32 v74, v78
  v_permlane16_swap_b32 v75, v79
  v_exp_f32 v160, v160
  v_exp_f32 v161, v161
  v_exp_f32 v162, v162
  v_exp_f32 v163, v163
  v_exp_f32 v164, v164
  v_exp_f32 v165, v165
  v_exp_f32 v166, v166
  v_exp_f32 v167, v167
  v_exp_f32 v168, v168
  v_exp_f32 v169, v169
  v_exp_f32 v170, v170
  v_exp_f32 v171, v171
  v_exp_f32 v172, v172
  v_exp_f32 v173, v173
  v_exp_f32 v174, v174
  v_exp_f32 v175, v175
  v_cvt_pk_bf16_f32 v208, v160, v161
  v_cvt_pk_bf16_f32 v209, v162, v163
  v_cvt_pk_bf16_f32 v210, v164, v165
  v_cvt_pk_bf16_f32 v211, v166, v167
  v_cvt_pk_bf16_f32 v212, v168, v169
  v_cvt_pk_bf16_f32 v213, v170, v171
  v_cvt_pk_bf16_f32 v214, v172, v173
  v_cvt_pk_bf16_f32 v215, v174, v175
  v_mfma_f32_32x32x16_bf16 v[216:231], v[72:75], v[208:211], v[216:231]
  s_nop 0
  v_mfma_f32_32x32x16_bf16 v[216:231], v[76:79], v[212:215], v[216:231]
  s_waitcnt vmcnt(2)
  v_permlane16_swap_b32 v64, v68
  v_permlane16_swap_b32 v65, v69
  v_permlane16_swap_b32 v66, v70
  v_permlane16_swap_b32 v67, v71
  v_exp_f32 v144, v144
  v_exp_f32 v145, v145
  v_exp_f32 v146, v146
  v_exp_f32 v147, v147
  v_exp_f32 v148, v148
  v_exp_f32 v149, v149
  v_exp_f32 v150, v150
  v_exp_f32 v151, v151
  v_exp_f32 v152, v152
  v_exp_f32 v153, v153
  v_exp_f32 v154, v154
  v_exp_f32 v155, v155
  v_exp_f32 v156, v156
  v_exp_f32 v157, v157
  v_exp_f32 v158, v158
  v_exp_f32 v159, v159
  v_cvt_pk_bf16_f32 v208, v144, v145
  v_cvt_pk_bf16_f32 v209, v146, v147
  v_cvt_pk_bf16_f32 v210, v148, v149
  v_cvt_pk_bf16_f32 v211, v150, v151
  v_cvt_pk_bf16_f32 v212, v152, v153
  v_cvt_pk_bf16_f32 v213, v154, v155
  v_cvt_pk_bf16_f32 v214, v156, v157
  v_cvt_pk_bf16_f32 v215, v158, v159
  v_mfma_f32_32x32x16_bf16 v[216:231], v[64:67], v[208:211], v[216:231]
  s_nop 0
  v_mfma_f32_32x32x16_bf16 v[216:231], v[68:71], v[212:215], v[216:231]
  s_nop 11
  v_rcp_f32 v6, v224
  s_nop 0
  v_mul_f32 v216, v216, v6
  v_mul_f32 v217, v217, v6
  v_mul_f32 v218, v218, v6
  v_mul_f32 v219, v219, v6
  v_mul_f32 v220, v220, v6
  v_mul_f32 v221, v221, v6
  v_mul_f32 v222, v222, v6
  v_mul_f32 v223, v223, v6
  v_cvt_pk_bf16_f32 v8, v216, v217
  v_cvt_pk_bf16_f32 v9, v218, v219
  v_cvt_pk_bf16_f32 v10, v220, v221
  v_cvt_pk_bf16_f32 v11, v222, v223
  s_lshl_b32 s36, s21, 6
  s_add_u32 s36, s36, s40
  s_lshl_b32 s36, s36, 10
  s_add_u32 s36, s36, 14680064
  buffer_store_dwordx4 v[8:11], v14, s[16:19], s36 offen sc1
  v_mov_b32 v5, v4
  v_cndmask_b32 v192, v4, 0, s[64:65]
  v_cndmask_b32 v193, v4, 0, s[66:67]
  v_cndmask_b32 v194, v4, 0, s[68:69]
  v_cndmask_b32 v195, v4, 0, s[70:71]
  v_cndmask_b32 v196, v4, 0, s[72:73]
  v_cndmask_b32 v197, v4, 0, s[74:75]
  v_cndmask_b32 v198, v4, 0, s[76:77]
  v_cndmask_b32 v199, v4, 0, s[78:79]
  v_cndmask_b32 v200, v4, 0, s[80:81]
  v_cndmask_b32 v201, v4, 0, s[82:83]
  v_cndmask_b32 v202, v4, 0, s[84:85]
  v_cndmask_b32 v203, v4, 0, s[86:87]
  v_cndmask_b32 v204, v4, 0, s[88:89]
  v_cndmask_b32 v205, v4, 0, s[90:91]
  v_cndmask_b32 v206, v4, 0, s[92:93]
  v_cndmask_b32 v207, v4, 0, s[94:95]
  s_nop 1
  v_mfma_f32_32x32x16_bf16 v[144:159], v[60:63], v[20:23], v[192:207]
  v_mfma_f32_32x32x16_bf16 v[160:175], v[56:59], v[20:23], 0
  s_nop 10
  v_max3_f32 v5, v144, v145, v5
  v_max3_f32 v5, v146, v147, v5
  v_max3_f32 v5, v148, v149, v5
  v_max3_f32 v5, v150, v151, v5
  v_max3_f32 v5, v152, v153, v5
  v_max3_f32 v5, v154, v155, v5
  v_max3_f32 v5, v156, v157, v5
  v_max3_f32 v5, v158, v159, v5
  v_mfma_f32_32x32x16_bf16 v[144:159], v[52:55], v[20:23], 0
  v_max3_f32 v5, v160, v161, v5
  v_max3_f32 v5, v162, v163, v5
  v_max3_f32 v5, v164, v165, v5
  v_max3_f32 v5, v166, v167, v5
  v_max3_f32 v5, v168, v169, v5
  v_max3_f32 v5, v170, v171, v5
  v_max3_f32 v5, v172, v173, v5
  v_max3_f32 v5, v174, v175, v5
  v_mfma_f32_32x32x16_bf16 v[160:175], v[48:51], v[20:23], 0
  s_nop 2
  v_max3_f32 v5, v144, v145, v5
  v_max3_f32 v5, v146, v147, v5
  v_max3_f32 v5, v148, v149, v5
  v_max3_f32 v5, v150, v151, v5
  v_max3_f32 v5, v152, v153, v5
  v_max3_f32 v5, v154, v155, v5
  v_max3_f32 v5, v156, v157, v5
  v_max3_f32 v5, v158, v159, v5
  v_mfma_f32_32x32x16_bf16 v[144:159], v[44:47], v[20:23], 0
  v_max3_f32 v5, v160, v161, v5
  v_max3_f32 v5, v162, v163, v5
  v_max3_f32 v5, v164, v165, v5
  v_max3_f32 v5, v166, v167, v5
  v_max3_f32 v5, v168, v169, v5
  v_max3_f32 v5, v170, v171, v5
  v_max3_f32 v5, v172, v173, v5
  v_max3_f32 v5, v174, v175, v5
  v_mfma_f32_32x32x16_bf16 v[160:175], v[40:43], v[20:23], 0
  s_nop 2
  v_max3_f32 v5, v144, v145, v5
  v_max3_f32 v5, v146, v147, v5
  v_max3_f32 v5, v148, v149, v5
  v_max3_f32 v5, v150, v151, v5
  v_max3_f32 v5, v152, v153, v5
  v_max3_f32 v5, v154, v155, v5
  v_max3_f32 v5, v156, v157, v5
  v_max3_f32 v5, v158, v159, v5
  v_mfma_f32_32x32x16_bf16 v[144:159], v[36:39], v[20:23], 0
  v_max3_f32 v5, v160, v161, v5
  v_max3_f32 v5, v162, v163, v5
  v_max3_f32 v5, v164, v165, v5
  v_max3_f32 v5, v166, v167, v5
  v_max3_f32 v5, v168, v169, v5
  v_max3_f32 v5, v170, v171, v5
  v_max3_f32 v5, v172, v173, v5
  v_max3_f32 v5, v174, v175, v5
  v_mfma_f32_32x32x16_bf16 v[160:175], v[32:35], v[20:23], 0
  s_nop 2
  v_max3_f32 v5, v144, v145, v5
  v_max3_f32 v5, v146, v147, v5
  v_max3_f32 v5, v148, v149, v5
  v_max3_f32 v5, v150, v151, v5
  v_max3_f32 v5, v152, v153, v5
  v_max3_f32 v5, v154, v155, v5
  v_max3_f32 v5, v156, v157, v5
  v_max3_f32 v5, v158, v159, v5
  v_cndmask_b32 v192, 0, v4, s[64:65]
  v_cndmask_b32 v193, 0, v4, s[66:67]
  v_cndmask_b32 v194, 0, v4, s[68:69]
  v_cndmask_b32 v195, 0, v4, s[70:71]
  v_cndmask_b32 v196, 0, v4, s[72:73]
  v_cndmask_b32 v197, 0, v4, s[74:75]
  v_cndmask_b32 v198, 0, v4, s[76:77]
  v_cndmask_b32 v199, 0, v4, s[78:79]
  v_cndmask_b32 v200, 0, v4, s[80:81]
  v_cndmask_b32 v201, 0, v4, s[82:83]
  v_cndmask_b32 v202, 0, v4, s[84:85]
  v_cndmask_b32 v203, 0, v4, s[86:87]
  v_cndmask_b32 v204, 0, v4, s[88:89]
  v_cndmask_b32 v205, 0, v4, s[90:91]
  v_cndmask_b32 v206, 0, v4, s[92:93]
  v_cndmask_b32 v207, 0, v4, s[94:95]
  s_nop 1
  v_mfma_f32_32x32x16_bf16 v[144:159], v[28:31], v[20:23], v[192:207]
  v_max3_f32 v5, v160, v161, v5
  v_max3_f32 v5, v162, v163, v5
  v_max3_f32 v5, v164, v165, v5
  v_max3_f32 v5, v166, v167, v5
  v_max3_f32 v5, v168, v169, v5
  v_max3_f32 v5, v170, v171, v5
  v_max3_f32 v5, v172, v173, v5
  v_max3_f32 v5, v174, v175, v5
  s_nop 3
  v_max3_f32 v5, v144, v145, v5
  v_max3_f32 v5, v146, v147, v5
  v_max3_f32 v5, v148, v149, v5
  v_max3_f32 v5, v150, v151, v5
  v_max3_f32 v5, v152, v153, v5
  v_max3_f32 v5, v154, v155, v5
  v_max3_f32 v5, v156, v157, v5
  v_max3_f32 v5, v158, v159, v5
  v_mov_b32 v6, v5
  s_nop 1
  v_permlane32_swap_b32 v5, v6
  v_max_f32 v5, v5, v6
  v_sub_f32 v176, 0, v5
  v_mov_b32 v177, v176
  v_mov_b32 v178, v176
  v_mov_b32 v179, v176
  v_mov_b32 v180, v176
  v_mov_b32 v181, v176
  v_mov_b32 v182, v176
  v_mov_b32 v183, v176
  v_mov_b32 v184, v176
  v_mov_b32 v185, v176
  v_mov_b32 v186, v176
  v_mov_b32 v187, v176
  v_mov_b32 v188, v176
  v_mov_b32 v189, v176
  v_mov_b32 v190, v176
  v_mov_b32 v191, v176
  v_cndmask_b32 v192, v4, v176, s[64:65]
  v_cndmask_b32 v193, v4, v176, s[66:67]
  v_cndmask_b32 v194, v4, v176, s[68:69]
  v_cndmask_b32 v195, v4, v176, s[70:71]
  v_cndmask_b32 v196, v4, v176, s[72:73]
  v_cndmask_b32 v197, v4, v176, s[74:75]
  v_cndmask_b32 v198, v4, v176, s[76:77]
  v_cndmask_b32 v199, v4, v176, s[78:79]
  v_cndmask_b32 v200, v4, v176, s[80:81]
  v_cndmask_b32 v201, v4, v176, s[82:83]
  v_cndmask_b32 v202, v4, v176, s[84:85]
  v_cndmask_b32 v203, v4, v176, s[86:87]
  v_cndmask_b32 v204, v4, v176, s[88:89]
  v_cndmask_b32 v205, v4, v176, s[90:91]
  v_cndmask_b32 v206, v4, v176, s[92:93]
  v_cndmask_b32 v207, v4, v176, s[94:95]
  s_nop 1
  v_mfma_f32_32x32x16_bf16 v[144:159], v[60:63], v[20:23], v[192:207]
  v_mfma_f32_32x32x16_bf16 v[160:175], v[56:59], v[20:23], v[176:191]
  s_waitcnt vmcnt(2)
  v_permlane16_swap_b32 v136, v140
  v_permlane16_swap_b32 v137, v141
  v_permlane16_swap_b32 v138, v142
  v_permlane16_swap_b32 v139, v143
  s_nop 5
  v_exp_f32 v144, v144
  v_exp_f32 v145, v145
  v_exp_f32 v146, v146
  v_exp_f32 v147, v147
  v_exp_f32 v148, v148
  v_exp_f32 v149, v149
  v_exp_f32 v150, v150
  v_exp_f32 v151, v151
  v_exp_f32 v152, v152
  v_exp_f32 v153, v153
  v_exp_f32 v154, v154
  v_exp_f32 v155, v155
  v_exp_f32 v156, v156
  v_exp_f32 v157, v157
  v_exp_f32 v158, v158
  v_exp_f32 v159, v159
  v_cvt_pk_bf16_f32 v208, v144, v145
  v_cvt_pk_bf16_f32 v209, v146, v147
  v_cvt_pk_bf16_f32 v210, v148, v149
  v_cvt_pk_bf16_f32 v211, v150, v151
  v_cvt_pk_bf16_f32 v212, v152, v153
  v_cvt_pk_bf16_f32 v213, v154, v155
  v_cvt_pk_bf16_f32 v214, v156, v157
  v_cvt_pk_bf16_f32 v215, v158, v159
  v_mfma_f32_32x32x16_bf16 v[216:231], v[136:139], v[208:211], 0
  s_nop 0
  v_mfma_f32_32x32x16_bf16 v[216:231], v[140:143], v[212:215], v[216:231]
  v_mfma_f32_32x32x16_bf16 v[144:159], v[52:55], v[20:23], v[176:191]
  v_exp_f32 v160, v160
  v_exp_f32 v161, v161
  v_exp_f32 v162, v162
  v_exp_f32 v163, v163
  v_exp_f32 v164, v164
  v_exp_f32 v165, v165
  v_exp_f32 v166, v166
  v_exp_f32 v167, v167
  v_exp_f32 v168, v168
  v_exp_f32 v169, v169
  v_exp_f32 v170, v170
  v_exp_f32 v171, v171
  v_exp_f32 v172, v172
  v_exp_f32 v173, v173
  v_exp_f32 v174, v174
  v_exp_f32 v175, v175
  v_cvt_pk_bf16_f32 v208, v160, v161
  v_cvt_pk_bf16_f32 v209, v162, v163
  v_cvt_pk_bf16_f32 v210, v164, v165
  v_cvt_pk_bf16_f32 v211, v166, v167
  v_cvt_pk_bf16_f32 v212, v168, v169
  v_cvt_pk_bf16_f32 v213, v170, v171
  v_cvt_pk_bf16_f32 v214, v172, v173
  v_cvt_pk_bf16_f32 v215, v174, v175
  v_mfma_f32_32x32x16_bf16 v[216:231], v[128:131], v[208:211], v[216:231]
  s_nop 0
  v_mfma_f32_32x32x16_bf16 v[216:231], v[132:135], v[212:215], v[216:231]
  v_mfma_f32_32x32x16_bf16 v[160:175], v[48:51], v[20:23], v[176:191]
  v_exp_f32 v144, v144
  v_exp_f32 v145, v145
  v_exp_f32 v146, v146
  v_exp_f32 v147, v147
  v_exp_f32 v148, v148
  v_exp_f32 v149, v149
  v_exp_f32 v150, v150
  v_exp_f32 v151, v151
  v_exp_f32 v152, v152
  v_exp_f32 v153, v153
  v_exp_f32 v154, v154
  v_exp_f32 v155, v155
  v_exp_f32 v156, v156
  v_exp_f32 v157, v157
  v_exp_f32 v158, v158
  v_exp_f32 v159, v159
  v_cvt_pk_bf16_f32 v208, v144, v145
  v_cvt_pk_bf16_f32 v209, v146, v147
  v_cvt_pk_bf16_f32 v210, v148, v149
  v_cvt_pk_bf16_f32 v211, v150, v151
  v_cvt_pk_bf16_f32 v212, v152, v153
  v_cvt_pk_bf16_f32 v213, v154, v155
  v_cvt_pk_bf16_f32 v214, v156, v157
  v_cvt_pk_bf16_f32 v215, v158, v159
  v_mfma_f32_32x32x16_bf16 v[216:231], v[120:123], v[208:211], v[216:231]
  s_nop 0
  v_mfma_f32_32x32x16_bf16 v[216:231], v[124:127], v[212:215], v[216:231]
  v_mfma_f32_32x32x16_bf16 v[144:159], v[44:47], v[20:23], v[176:191]
  v_exp_f32 v160, v160
  v_exp_f32 v161, v161
  v_exp_f32 v162, v162
  v_exp_f32 v163, v163
  v_exp_f32 v164, v164
  v_exp_f32 v165, v165
  v_exp_f32 v166, v166
  v_exp_f32 v167, v167
  v_exp_f32 v168, v168
  v_exp_f32 v169, v169
  v_exp_f32 v170, v170
  v_exp_f32 v171, v171
  v_exp_f32 v172, v172
  v_exp_f32 v173, v173
  v_exp_f32 v174, v174
  v_exp_f32 v175, v175
  v_cvt_pk_bf16_f32 v208, v160, v161
  v_cvt_pk_bf16_f32 v209, v162, v163
  v_cvt_pk_bf16_f32 v210, v164, v165
  v_cvt_pk_bf16_f32 v211, v166, v167
  v_cvt_pk_bf16_f32 v212, v168, v169
  v_cvt_pk_bf16_f32 v213, v170, v171
  v_cvt_pk_bf16_f32 v214, v172, v173
  v_cvt_pk_bf16_f32 v215, v174, v175
  v_mfma_f32_32x32x16_bf16 v[216:231], v[112:115], v[208:211], v[216:231]
  s_nop 0
  v_mfma_f32_32x32x16_bf16 v[216:231], v[116:119], v[212:215], v[216:231]
  v_mfma_f32_32x32x16_bf16 v[160:175], v[40:43], v[20:23], v[176:191]
  v_exp_f32 v144, v144
  v_exp_f32 v145, v145
  v_exp_f32 v146, v146
  v_exp_f32 v147, v147
  v_exp_f32 v148, v148
  v_exp_f32 v149, v149
  v_exp_f32 v150, v150
  v_exp_f32 v151, v151
  v_exp_f32 v152, v152
  v_exp_f32 v153, v153
  v_exp_f32 v154, v154
  v_exp_f32 v155, v155
  v_exp_f32 v156, v156
  v_exp_f32 v157, v157
  v_exp_f32 v158, v158
  v_exp_f32 v159, v159
  v_cvt_pk_bf16_f32 v208, v144, v145
  v_cvt_pk_bf16_f32 v209, v146, v147
  v_cvt_pk_bf16_f32 v210, v148, v149
  v_cvt_pk_bf16_f32 v211, v150, v151
  v_cvt_pk_bf16_f32 v212, v152, v153
  v_cvt_pk_bf16_f32 v213, v154, v155
  v_cvt_pk_bf16_f32 v214, v156, v157
  v_cvt_pk_bf16_f32 v215, v158, v159
  v_mfma_f32_32x32x16_bf16 v[216:231], v[104:107], v[208:211], v[216:231]
  s_nop 0
  v_mfma_f32_32x32x16_bf16 v[216:231], v[108:111], v[212:215], v[216:231]
  v_mfma_f32_32x32x16_bf16 v[144:159], v[36:39], v[20:23], v[176:191]
  v_exp_f32 v160, v160
  v_exp_f32 v161, v161
  v_exp_f32 v162, v162
  v_exp_f32 v163, v163
  v_exp_f32 v164, v164
  v_exp_f32 v165, v165
  v_exp_f32 v166, v166
  v_exp_f32 v167, v167
  v_exp_f32 v168, v168
  v_exp_f32 v169, v169
  v_exp_f32 v170, v170
  v_exp_f32 v171, v171
  v_exp_f32 v172, v172
  v_exp_f32 v173, v173
  v_exp_f32 v174, v174
  v_exp_f32 v175, v175
  v_cvt_pk_bf16_f32 v208, v160, v161
  v_cvt_pk_bf16_f32 v209, v162, v163
  v_cvt_pk_bf16_f32 v210, v164, v165
  v_cvt_pk_bf16_f32 v211, v166, v167
  v_cvt_pk_bf16_f32 v212, v168, v169
  v_cvt_pk_bf16_f32 v213, v170, v171
  v_cvt_pk_bf16_f32 v214, v172, v173
  v_cvt_pk_bf16_f32 v215, v174, v175
  v_mfma_f32_32x32x16_bf16 v[216:231], v[96:99], v[208:211], v[216:231]
  s_nop 0
  v_mfma_f32_32x32x16_bf16 v[216:231], v[100:103], v[212:215], v[216:231]
  v_mfma_f32_32x32x16_bf16 v[160:175], v[32:35], v[20:23], v[176:191]
  v_exp_f32 v144, v144
  v_exp_f32 v145, v145
  v_exp_f32 v146, v146
  v_exp_f32 v147, v147
  v_exp_f32 v148, v148
  v_exp_f32 v149, v149
  v_exp_f32 v150, v150
  v_exp_f32 v151, v151
  v_exp_f32 v152, v152
  v_exp_f32 v153, v153
  v_exp_f32 v154, v154
  v_exp_f32 v155, v155
  v_exp_f32 v156, v156
  v_exp_f32 v157, v157
  v_exp_f32 v158, v158
  v_exp_f32 v159, v159
  v_cvt_pk_bf16_f32 v208, v144, v145
  v_cvt_pk_bf16_f32 v209, v146, v147
  v_cvt_pk_bf16_f32 v210, v148, v149
  v_cvt_pk_bf16_f32 v211, v150, v151
  v_cvt_pk_bf16_f32 v212, v152, v153
  v_cvt_pk_bf16_f32 v213, v154, v155
  v_cvt_pk_bf16_f32 v214, v156, v157
  v_cvt_pk_bf16_f32 v215, v158, v159
  v_mfma_f32_32x32x16_bf16 v[216:231], v[88:91], v[208:211], v[216:231]
  s_nop 0
  v_mfma_f32_32x32x16_bf16 v[216:231], v[92:95], v[212:215], v[216:231]
  v_cndmask_b32 v192, v176, v4, s[64:65]
  v_cndmask_b32 v193, v176, v4, s[66:67]
  v_cndmask_b32 v194, v176, v4, s[68:69]
  v_cndmask_b32 v195, v176, v4, s[70:71]
  v_cndmask_b32 v196, v176, v4, s[72:73]
  v_cndmask_b32 v197, v176, v4, s[74:75]
  v_cndmask_b32 v198, v176, v4, s[76:77]
  v_cndmask_b32 v199, v176, v4, s[78:79]
  v_cndmask_b32 v200, v176, v4, s[80:81]
  v_cndmask_b32 v201, v176, v4, s[82:83]
  v_cndmask_b32 v202, v176, v4, s[84:85]
  v_cndmask_b32 v203, v176, v4, s[86:87]
  v_cndmask_b32 v204, v176, v4, s[88:89]
  v_cndmask_b32 v205, v176, v4, s[90:91]
  v_cndmask_b32 v206, v176, v4, s[92:93]
  v_cndmask_b32 v207, v176, v4, s[94:95]
  s_nop 1
  v_mfma_f32_32x32x16_bf16 v[144:159], v[28:31], v[20:23], v[192:207]
  v_exp_f32 v160, v160
  v_exp_f32 v161, v161
  v_exp_f32 v162, v162
  v_exp_f32 v163, v163
  v_exp_f32 v164, v164
  v_exp_f32 v165, v165
  v_exp_f32 v166, v166
  v_exp_f32 v167, v167
  v_exp_f32 v168, v168
  v_exp_f32 v169, v169
  v_exp_f32 v170, v170
  v_exp_f32 v171, v171
  v_exp_f32 v172, v172
  v_exp_f32 v173, v173
  v_exp_f32 v174, v174
  v_exp_f32 v175, v175
  v_cvt_pk_bf16_f32 v208, v160, v161
  v_cvt_pk_bf16_f32 v209, v162, v163
  v_cvt_pk_bf16_f32 v210, v164, v165
  v_cvt_pk_bf16_f32 v211, v166, v167
  v_cvt_pk_bf16_f32 v212, v168, v169
  v_cvt_pk_bf16_f32 v213, v170, v171
  v_cvt_pk_bf16_f32 v214, v172, v173
  v_cvt_pk_bf16_f32 v215, v174, v175
  v_mfma_f32_32x32x16_bf16 v[216:231], v[80:83], v[208:211], v[216:231]
  s_nop 0
  v_mfma_f32_32x32x16_bf16 v[216:231], v[84:87], v[212:215], v[216:231]
  v_exp_f32 v144, v144
  v_exp_f32 v145, v145
  v_exp_f32 v146, v146
  v_exp_f32 v147, v147
  v_exp_f32 v148, v148
  v_exp_f32 v149, v149
  v_exp_f32 v150, v150
  v_exp_f32 v151, v151
  v_exp_f32 v152, v152
  v_exp_f32 v153, v153
  v_exp_f32 v154, v154
  v_exp_f32 v155, v155
  v_exp_f32 v156, v156
  v_exp_f32 v157, v157
  v_exp_f32 v158, v158
  v_exp_f32 v159, v159
  v_cvt_pk_bf16_f32 v208, v144, v145
  v_cvt_pk_bf16_f32 v209, v146, v147
  v_cvt_pk_bf16_f32 v210, v148, v149
  v_cvt_pk_bf16_f32 v211, v150, v151
  v_cvt_pk_bf16_f32 v212, v152, v153
  v_cvt_pk_bf16_f32 v213, v154, v155
  v_cvt_pk_bf16_f32 v214, v156, v157
  v_cvt_pk_bf16_f32 v215, v158, v159
  v_mfma_f32_32x32x16_bf16 v[216:231], v[72:75], v[208:211], v[216:231]
  s_nop 0
  v_mfma_f32_32x32x16_bf16 v[216:231], v[76:79], v[212:215], v[216:231]
  s_nop 11
  v_rcp_f32 v6, v224
  s_nop 0
  v_mul_f32 v216, v216, v6
  v_mul_f32 v217, v217, v6
  v_mul_f32 v218, v218, v6
  v_mul_f32 v219, v219, v6
  v_mul_f32 v220, v220, v6
  v_mul_f32 v221, v221, v6
  v_mul_f32 v222, v222, v6
  v_mul_f32 v223, v223, v6
  v_cvt_pk_bf16_f32 v8, v216, v217
  v_cvt_pk_bf16_f32 v9, v218, v219
  v_cvt_pk_bf16_f32 v10, v220, v221
  v_cvt_pk_bf16_f32 v11, v222, v223
  s_lshl_b32 s36, s21, 6
  s_add_u32 s36, s36, s40
  s_lshl_b32 s36, s36, 10
  s_add_u32 s36, s36, 14712832
  buffer_store_dwordx4 v[8:11], v14, s[16:19], s36 offen sc1
K2_AJOIN:
  s_waitcnt vmcnt(0)
  s_lshl_b32 s37, s21, 7
  s_add_u32 s37, s37, 20971520
  s_lshl_b32 s36, s40, 2
  s_and_b32 s36, s36, 127
  v_mov_b32 v5, s36
  v_mov_b32 v6, 1
  s_mov_b64 exec, 1
  buffer_store_dword v6, v5, s[16:19], s37 offen sc1
  s_mov_b64 exec, -1
  s_cmp_lg_u32 s20, 4
  s_cbranch_scc1 K2_AFIN
  v_mov_b32 v8, 69632
K2_GATE:
  ds_read_b32 v9, v8 offset:12
  s_waitcnt lgkmcnt(0)
  v_readfirstlane_b32 s52, v9
  s_nop 0
  s_cmp_lg_u32 s52, 0
  s_cbranch_scc1 K2_GATE_OK
  s_sleep 1
  s_branch K2_GATE
K2_GATE_OK:
  v_and_b32 v5, 31, v0
  v_lshlrev_b32 v5, 2, v5
  s_mov_b32 s53, 0
K2_POLL:
  buffer_load_dword v7, v5, s[16:19], s37 offen sc1
  s_waitcnt vmcnt(0)
  v_cmp_ne_u32 vcc, 0, v7
  s_nop 0
  s_cmp_eq_u64 vcc, -1
  s_cbranch_scc1 K2_PDONE
  s_add_u32 s53, s53, 1
  s_cmp_gt_u32 s53, 0x100000
  s_cbranch_scc1 K2_PDONE
  s_sleep 1
  s_branch K2_POLL
K2_PDONE:
  v_mov_b32 v5, 69632
  ds_write_b32 v5, v6
  s_waitcnt lgkmcnt(0)
K2_AFIN:
  v_add_u32 v11, 34816, v12
  s_barrier
  ds_read_b128 v[192:195], v12 offset:0
  ds_read_b128 v[196:199], v12 offset:16
  ds_read_b128 v[200:203], v12 offset:17408
  ds_read_b128 v[204:207], v12 offset:17424
  ds_read_b128 v[208:211], v11 offset:0
  ds_read_b128 v[212:215], v11 offset:16
  ds_read_b128 v[216:219], v11 offset:17408
  ds_read_b128 v[220:223], v11 offset:17424
  v_lshlrev_b32 v64, 16, v232
  v_and_b32 v65, 0xffff0000, v232
  v_lshlrev_b32 v66, 16, v233
  v_and_b32 v67, 0xffff0000, v233
  v_lshlrev_b32 v68, 16, v234
  v_and_b32 v69, 0xffff0000, v234
  v_lshlrev_b32 v70, 16, v235
  v_and_b32 v71, 0xffff0000, v235
  s_waitcnt lgkmcnt(0)
  v_add_f32 v192, v192, v200
  v_add_f32 v193, v193, v201
  v_add_f32 v194, v194, v202
  v_add_f32 v195, v195, v203
  v_add_f32 v196, v196, v204
  v_add_f32 v197, v197, v205
  v_add_f32 v198, v198, v206
  v_add_f32 v199, v199, v207
  v_add_f32 v208, v208, v216
  v_add_f32 v209, v209, v217
  v_add_f32 v210, v210, v218
  v_add_f32 v211, v211, v219
  v_add_f32 v212, v212, v220
  v_add_f32 v213, v213, v221
  v_add_f32 v214, v214, v222
  v_add_f32 v215, v215, v223
  v_add_f32 v192, v192, v208
  v_add_f32 v193, v193, v209
  v_add_f32 v194, v194, v210
  v_add_f32 v195, v195, v211
  v_add_f32 v196, v196, v212
  v_add_f32 v197, v197, v213
  v_add_f32 v198, v198, v214
  v_add_f32 v199, v199, v215
  v_add_f32 v192, v192, v64
  v_add_f32 v193, v193, v65
  v_add_f32 v194, v194, v66
  v_add_f32 v195, v195, v67
  v_add_f32 v196, v196, v68
  v_add_f32 v197, v197, v69
  v_add_f32 v198, v198, v70
  v_add_f32 v199, v199, v71
  v_cvt_pk_bf16_f32 v72, v192, v193
  v_cvt_pk_bf16_f32 v73, v194, v195
  v_cvt_pk_bf16_f32 v74, v196, v197
  v_cvt_pk_bf16_f32 v75, v198, v199
  buffer_store_dwordx4 v[72:75], v13, s[28:31], s23 offen sc1
  s_endpgm
K2_END:
  s_endpgm
CODE_END:
 s_endpgm
.section .rodata,"a"
.p2align 6
.amdhsa_kernel k1_kernel
  .amdhsa_next_free_vgpr 256
  .amdhsa_next_free_sgpr 102
  .amdhsa_accum_offset 256
  .amdhsa_group_segment_fixed_size 0
  .amdhsa_kernarg_size 80
  .amdhsa_user_sgpr_count 2
  .amdhsa_user_sgpr_kernarg_segment_ptr 1
  .amdhsa_system_sgpr_workgroup_id_x 1
.end_amdhsa_kernel
.section .rodata,"a"
.p2align 6
.amdhsa_kernel k2_kernel
  .amdhsa_next_free_vgpr 256
  .amdhsa_next_free_sgpr 102
  .amdhsa_accum_offset 256
  .amdhsa_group_segment_fixed_size 0
  .amdhsa_kernarg_size 80
  .amdhsa_user_sgpr_count 2
  .amdhsa_user_sgpr_kernarg_segment_ptr 1
  .amdhsa_system_sgpr_workgroup_id_x 1
.end_amdhsa_kernel
```
